```python
import torch

def _softmax(x, axis=-1):
    return torch.softmax(x, dim=axis)
def _gelu(x):
    return torch.nn.functional.gelu(x, approximate="tanh")
def _silu(x):
    return torch.nn.functional.silu(x)
def _sigmoid(x):
    return torch.sigmoid(x)
def _layernorm(x, axis=-1, eps=1e-5):
    m = x.mean(dim=axis, keepdim=True)
    v = x.var(dim=axis, keepdim=True, unbiased=False)
    return (x - m) / torch.sqrt(v + eps)
def _scatter_add(tgt, idx, src, axis=0):
    return tgt.clone().index_add_(axis, idx, src)
def _segment_sum(src, seg, n):
    out = torch.zeros((n,) + src.shape[1:], dtype=src.dtype)
    return out.index_add_(0, seg, src)
def _pad(x, pw):
    flat = tuple(v for pair in reversed(pw) for v in pair)
    return torch.nn.functional.pad(x, flat)

kernel_name = 'interleave_layers__sliding_block_cached__glu_gated_bilinear__decode'

def setup_inputs():

    _w = (lambda a: (lambda t: t.to(torch.bfloat16) if t.is_floating_point() else t)(torch.as_tensor(a)))
    def _A_setup():
        B, Sq, D = 1, 1, 512
        Hq, Hkv, Sk, Dh = 32, 8, 65536, 128
        assert Hq % Hkv == 0, (Hq, Hkv)
        return {
            "x": _w((lambda *s: torch.randn(*s, dtype=torch.bfloat16) * 0.05)(B, Sq, D)),
            "k_cache": _w((lambda *s: torch.randn(*s, dtype=torch.bfloat16) * 0.8)(B, Hkv, Sk, Dh)),
            "v_cache": _w((lambda *s: torch.randn(*s, dtype=torch.bfloat16) * 0.8)(B, Hkv, Sk, Dh)),
            "wq": _w((lambda *s: torch.randn(*s, dtype=torch.bfloat16) * 0.8)(D, Hq * Dh) * (D ** -0.5)),
            "wo": _w((lambda *s: torch.randn(*s, dtype=torch.bfloat16) * 0.8)(Hq * Dh, D) * ((Hq * Dh) ** -0.5)),
        }
    _A_in = _A_setup()

    def _B_setup():
        B, S, D, F = 1, 1, 512, 1792
        return {
            "x": _w((lambda *s: torch.randn(*s, dtype=torch.bfloat16) * 0.05)(B, S, D)),
            "w_gate": _w((lambda *s: torch.randn(*s, dtype=torch.bfloat16) * 0.2)(D, F) * (D ** -0.5)),
            "w_up": _w((lambda *s: torch.randn(*s, dtype=torch.bfloat16) * 0.2)(D, F) * (D ** -0.5)),
            "w_down": _w((lambda *s: torch.randn(*s, dtype=torch.bfloat16) * 0.2)(F, D) * (F ** -0.5)),
        }
    _B_in = _B_setup()

    return {
        "A_x": _A_in["x"],
        "A_k_cache": _A_in["k_cache"],
        "A_v_cache": _A_in["v_cache"],
        "A_wq": _A_in["wq"],
        "A_wo": _A_in["wo"],
        "B_x": _B_in["x"],
        "B_w_gate": _B_in["w_gate"],
        "B_w_up": _B_in["w_up"],
        "B_w_down": _B_in["w_down"],
    }

def reference(A_x, A_k_cache, A_v_cache, A_wq, A_wo, B_x, B_w_gate, B_w_up, B_w_down):
    def _A_ref(x, k_cache, v_cache, wq, wo):
        B, Sq, D = x.shape
        Hq, Dh = 32, 128
        Hkv, Sk = k_cache.shape[1], k_cache.shape[2]
        W = min(4096, max(256, Sk // 4))
        rep = Hq // Hkv
        q = (lambda x, *d: x.permute(*d))((x @ wq).reshape(B, Sq, Hq, Dh), 0, 2, 1, 3)
        k = (lambda x, n, axis: torch.repeat_interleave(x, n, dim=axis))(k_cache[:, :, Sk - W:, :], rep, axis=1)
        v = (lambda x, n, axis: torch.repeat_interleave(x, n, dim=axis))(v_cache[:, :, Sk - W:, :], rep, axis=1)
        scores = torch.einsum("bhqd,bhkd->bhqk", q, k) * (Dh ** -0.5)
        p = _softmax(scores, axis=-1)
        o = torch.einsum("bhqk,bhkd->bhqd", p, v)
        return (lambda x, *d: x.permute(*d))(o, 0, 2, 1, 3).reshape(B, Sq, Hq * Dh) @ wo

    def _B_ref(x, w_gate, w_up, w_down):
        g = torch.einsum("bsd,df->bsf", x, w_gate)
        u = torch.einsum("bsd,df->bsf", x, w_up)
        h = g * u
        return torch.einsum("bsf,fd->bsd", h, w_down)

    x = A_x
    x = x + _A_ref(_layernorm(x, axis=-1), A_k_cache, A_v_cache, A_wq, A_wo)
    x = x + _B_ref(_layernorm(x, axis=-1), B_w_gate, B_w_up, B_w_down)
    x = x + _A_ref(_layernorm(x, axis=-1), A_k_cache, A_v_cache, A_wq, A_wo)
    x = x + _B_ref(_layernorm(x, axis=-1), B_w_gate, B_w_up, B_w_down)
    return x
```

```asm
; @launch grid=(256,1,1) block=(256,1,1) lds=122880
.amdgcn_target "amdgcn-amd-amdhsa--gfx950"
.text
.globl interleave_layers__sliding_block_cached__glu_gated_bilinear__decode_kernel
.p2align 8
.type interleave_layers__sliding_block_cached__glu_gated_bilinear__decode_kernel,@function
interleave_layers__sliding_block_cached__glu_gated_bilinear__decode_kernel:
    s_cmp_ge_u32 s2, 256
    s_cbranch_scc1 L_end
    s_getpc_b64 s[78:79]
L_pc:
    s_load_dwordx16 s[4:19], s[0:1], 0
    s_load_dwordx8 s[20:27], s[0:1], 64
    v_lshlrev_b32 v1, 7, v0
    v_min_u32 v1, L_end-L_pc, v1
    global_load_dword v60, v1, s[78:79]
    v_lshrrev_b32 v3, 6, v0
    v_lshrrev_b32 v4, 1, v0
    v_readfirstlane_b32 s30, v3
    v_xor_b32 v4, v4, v0
    v_lshlrev_b32 v5, 1, v4
    v_and_b32 v5, 32, v5
    v_and_or_b32 v5, v4, 64, v5
    v_lshlrev_b32 v11, 4, v0
    v_and_b32 v6, 0x70, v11
    v_xor_b32 v124, v5, v6
    v_lshrrev_b32 v123, 3, v0
    v_lshl_add_u32 v7, v123, 13, v124
    s_and_b32 s28, s2, 7
    s_lshr_b32 s29, s2, 3
    s_and_b32 s31, s29, 3
    s_lshr_b32 s32, s29, 2
    s_lshl_b32 s63, s31, 20
    s_lshl_b32 s64, s28, 10
    s_lshl3_add_u32 s64, s32, s64
    s_lshl_b32 s74, s30, 10
    s_add_u32 m0, s74, 8192
    s_mul_i32 s33, s32, 120
    s_add_u32 s63, s63, s64
    s_add_u32 s63, s63, s33
    s_waitcnt lgkmcnt(0)
    s_add_u32 s10, s10, s63
    s_addc_u32 s11, s11, 0
    global_load_lds_dwordx4 v7, s[10:11] nt
    s_add_u32 m0, m0, 4096
    v_add_u32 v7, 262144, v7
    global_load_lds_dwordx4 v7, s[10:11] nt
    s_add_u32 m0, m0, 4096
    v_add_u32 v7, 262144, v7
    global_load_lds_dwordx4 v7, s[10:11] nt
    s_add_u32 m0, m0, 4096
    v_add_u32 v7, 262144, v7
    global_load_lds_dwordx4 v7, s[10:11] nt
    s_load_dword s65, s[26:27], 0
    v_lshlrev_b32 v5, 1, v0
    v_and_b32 v5, 0xe0, v5
    v_xor_b32 v140, v11, v5
    v_and_b32 v140, 0x3ff, v140
    v_lshl_add_u32 v140, v3, 15, v140
    s_lshl_b32 s63, s28, 24
    s_lshl_b32 s64, s29, 10
    s_add_u32 s63, s63, s64
    s_add_u32 s63, s63, 0xF00000
    s_add_u32 s8, s8, s63
    s_addc_u32 s9, s9, 0
    s_add_u32 m0, s74, 24576
    s_add_u32 s6, s6, s63
    s_addc_u32 s7, s7, 0
    global_load_lds_dwordx4 v140, s[8:9] nt
    v_and_b32 v8, 31, v0
    v_bfe_u32 v9, v0, 5, 1
    v_lshlrev_b32 v8, 3, v8
    v_lshl_or_b32 v136, v9, 2, v8
    s_lshl_b32 s63, s31, 8
    v_add_u32 v10, s63, v136
    global_load_dword v110, v10, s[4:5]
    v_and_b32 v127, 0x3f0, v11
    global_load_dwordx4 v[20:23], v127, s[4:5]
    s_mul_i32 s63, s28, 128000
    s_add_u32 s63, s63, 8192
    s_add_u32 s36, s26, s63
    s_addc_u32 s37, s27, 0
    s_mul_i32 s63, s28, 41984
    s_add_u32 s63, s63, 2097152
    s_add_u32 s52, s26, s63
    s_addc_u32 s53, s27, 0
    s_lshl_b32 s63, s29, 10
    v_lshl_add_u32 v6, v6, 3, s63
    global_load_dword v61, v6, s[52:53] sc1
    v_mov_b32 v12, -1
    v_mov_b32 v13, -1
    v_mov_b32 v14, -1
    v_mov_b32 v15, -1
    s_mul_i32 s63, s29, 3328
    v_min_u32 v10, 3312, v11
    v_add_u32 v10, s63, v10
    global_store_dwordx4 v10, v[12:15], s[36:37]
    s_cmp_eq_u32 s30, 3
    s_cbranch_scc0 L_clrd
    s_mul_i32 s63, s29, 640
    s_add_u32 s63, s63, 106496
    v_min_u32 v10, 624, v127
    v_add_u32 v10, s63, v10
    global_store_dwordx4 v10, v[12:15], s[36:37] sc1
L_clrd:
    s_add_u32 m0, m0, 4096
    v_add_u32 v140, 131072, v140
    global_load_lds_dwordx4 v140, s[8:9] nt
    s_add_u32 m0, m0, 4096
    v_add_u32 v140, 131072, v140
    global_load_lds_dwordx4 v140, s[8:9] nt
    s_add_u32 m0, m0, 4096
    v_add_u32 v140, 131072, v140
    global_load_lds_dwordx4 v140, s[8:9] nt
    v_and_b32 v1, 15, v0
    v_bfe_u32 v2, v0, 4, 2
    s_mov_b32 s38, 0x20000
    s_mov_b32 s39, 0x20000
    s_mov_b64 s[40:41], s[26:27]
    s_mov_b32 s42, 4194304
    s_mov_b32 s43, 0x20000
    s_mov_b32 s54, 40960
    s_mov_b32 s55, 0x20000
    s_mov_b32 s34, 0
    s_mov_b32 s15, 1
    s_mov_b32 s14, 1
    s_mov_b32 s3, 0x42000000
    s_movk_i32 s77, 12
    s_mov_b32 s61, 0x20000
    s_mov_b32 s66, 0x11111111
    s_mov_b32 s67, 0x11111111
    s_mov_b32 s72, 0x00020002
    s_mov_b32 s73, 0x00020002
    s_mov_b32 s70, 0x00110011
    s_mov_b32 s71, 0x00110011
    s_lshl_b32 s63, s30, 4
    s_lshl_b64 s[68:69], 1, s63
    s_and_b32 s33, s29, 15
    s_or_b32 s63, s28, s32
    s_cmp_eq_u32 s63, 0
    s_cselect_b32 s76, 1, 0
    s_mov_b32 s78, 0
    s_brev_b32 s79, 1
    s_lshr_b32 s35, s33, 3
    s_mul_i32 s35, s35, 2560
    s_and_b32 s64, s33, 7
    s_lshl_b32 s64, s64, 8
    s_add_u32 s35, s35, s64
    s_mov_b32 s44, 0
    s_mov_b32 s45, 128000
    s_mov_b32 s46, 256000
    s_mov_b32 s47, 384000
    s_mov_b32 s48, 512000
    s_mov_b32 s49, 640000
    s_mov_b32 s50, 768000
    s_mov_b32 s51, 896000
    v_bfe_u32 v3, v0, 2, 2
    v_and_b32 v4, 3, v0
    v_lshrrev_b32 v128, 1, v127
    v_lshlrev_b32 v135, 4, v2
    v_add_u32 v5, 256, v135
    v_cmp_eq_u32 vcc, 1, v3
    v_mov_b32 v112, v136
    v_mov_b32 v57, 1065369472
    v_cndmask_b32 v111, v135, v5, vcc
    v_lshlrev_b32 v5, 1, v8
    s_lshl_b32 s63, s31, 9
    v_add_u32 v113, s63, v5
    v_mul_u32_u24 v6, 2560, v9
    v_add_u32 v113, v113, v6
    s_lshr_b32 s63, s33, 3
    s_lshl_b32 s63, s63, 12
    s_add_u32 s63, s63, 33792
    v_lshl_add_u32 v121, v9, 9, v5
    v_add_u32 v121, s63, v121
    v_lshlrev_b32 v137, 4, v4
    v_add_u32 v137, 41984, v137
    s_lshl_b32 s63, s31, 11
    s_lshl_b32 s64, s32, 8
    s_add_u32 s63, s63, s64
    s_lshl_b32 s64, s30, 6
    s_add_u32 s63, s63, s64
    v_add_u32 v114, s63, v135
    v_add_u32 v7, 9216, v114
    v_cndmask_b32 v114, v114, v7, vcc
    v_add_u32 v115, 8192, v5
    s_lshl_b32 s63, s29, 4
    s_add_u32 s63, s63, 8192
    v_mov_b32 v116, s63
    s_lshr_b32 s63, s29, 4
    s_lshl_b32 s63, s63, 12
    s_lshl_b32 s64, s30, 10
    s_add_u32 s63, s63, s64
    s_lshl_b32 s64, s33, 4
    s_add_u32 s63, s63, s64
    v_lshlrev_b32 v7, 13, v2
    v_lshl_add_u32 v7, v3, 8, v7
    v_add_u32 v117, s63, v7
    s_lshl_b32 s63, s29, 3
    s_add_u32 s63, s63, 32768
    v_lshlrev_b32 v7, 8, v2
    v_add_u32 v118, s63, v7
    s_lshr_b32 s63, s33, 3
    s_lshl_b32 s63, s63, 2
    s_add_u32 s63, s63, s30
    s_lshl_b32 s64, s63, 12
    v_add_u32 v119, s64, v127
    s_lshr_b32 s64, s63, 1
    s_lshl_b32 s64, s64, 8
    s_add_u32 s64, s64, 32768
    s_and_b32 s63, s63, 1
    v_and_b32 v7, 1, v3
    v_xor_b32 v7, s63, v7
    v_lshlrev_b32 v7, 4, v7
    v_lshl_add_u32 v7, v2, 2, v7
    v_add_u32 v7, v7, v4
    v_lshlrev_b32 v7, 3, v7
    v_add_u32 v120, s64, v7
    v_lshl_add_u32 v7, v2, 3, v3
    v_lshlrev_b32 v7, 7, v7
    v_lshrrev_b32 v10, 1, v2
    v_xor_b32 v10, v10, v2
    v_and_b32 v10, 1, v10
    v_lshrrev_b32 v11, 1, v3
    v_lshl_or_b32 v10, v10, 1, v11
    v_lshlrev_b32 v10, 5, v10
    v_lshl_or_b32 v10, v4, 3, v10
    v_or_b32 v125, v7, v10
    v_mul_u32_u24 v129, 320, v3
    v_add_u32 v129, v129, v135
    v_lshl_add_u32 v130, v3, 6, v135
    s_lshl_b32 s63, s30, 8
    v_add_u32 v131, s63, v130
    v_lshrrev_b32 v7, 1, v2
    v_and_b32 v10, 1, v2
    v_lshl_or_b32 v7, v10, 1, v7
    v_lshlrev_b32 v7, 6, v7
    v_lshl_add_u32 v7, v1, 2, v7
    v_add_u32 v134, s63, v7
    s_lshl_b32 s63, s30, 5
    v_lshlrev_b32 v7, 3, v2
    v_lshl_add_u32 v7, v3, 7, v7
    v_add_u32 v132, s63, v7
    v_lshlrev_b32 v7, 3, v1
    v_lshl_add_u32 v133, v2, 7, v7
    s_lshl_b32 s63, s30, 7
    v_lshl_add_u32 v7, v1, 6, v135
    v_add_u32 v138, s63, v7
    v_mov_b32 v122, 0
    v_mov_b32 v141, 0
    v_mov_b32 v56, 0xffffff00
    v_mov_b32 v58, 255
    v_lshrrev_b32 v11, 1, v128
    ds_write_b32 v11, v57 offset:256
    ds_write_b32 v11, v57 offset:768
    s_getreg_b32 s64, hwreg(HW_REG_XCC_ID)
    s_and_b32 s64, s64, 15
    v_mov_b32 v55, s64
    s_waitcnt lgkmcnt(0)
    s_mul_i32 s56, s65, 0x9E3779B1
    s_add_u32 s56, s56, 0x7F4A7C15
    s_and_b32 s57, s56, 255
    s_bfe_u32 s58, s56, 0x80008
    s_bfe_u32 s59, s56, 0x80010
    s_lshr_b32 s60, s56, 24
    v_mov_b32 v54, s56
    s_lshl_b32 s63, s30, 5
    v_xor_b32 v10, s63, v125
    v_xor_b32 v11, 32, v10
    v_add_u32 v11, 512, v11
    s_add_u32 m0, m0, 4096
    v_add_u32 v140, 131072, v140
    global_load_lds_dwordx4 v140, s[8:9] nt
    s_add_u32 m0, m0, 4096
    v_add_u32 v140, 131072, v140
    global_load_lds_dwordx4 v140, s[8:9] nt
    s_add_u32 m0, m0, 4096
    v_add_u32 v140, 131072, v140
    global_load_lds_dwordx4 v140, s[8:9] nt
    s_add_u32 m0, m0, 4096
    v_add_u32 v140, 131072, v140
    global_load_lds_dwordx4 v140, s[8:9] nt
    v_xor_b32 v142, v135, v127
    s_lshl_b32 s63, s30, 18
    v_add_u32 v142, s63, v142
    s_lshl_b32 s63, s30, 13
    s_add_u32 m0, s63, 90112
    s_waitcnt vmcnt(7)
    v_dot2_f32_bf16 v24, v20, v57, 0
    v_dot2_f32_bf16 v25, v20, v20, 0
    v_dot2_f32_bf16 v24, v21, v57, v24
    v_dot2_f32_bf16 v25, v21, v21, v25
    v_dot2_f32_bf16 v24, v22, v57, v24
    v_dot2_f32_bf16 v25, v22, v22, v25
    v_dot2_f32_bf16 v24, v23, v57, v24
    v_dot2_f32_bf16 v25, v23, v23, v25
    v_lshlrev_b32 v108, 16, v110
    v_and_b32 v109, 0xffff0000, v110
    s_nop 0
    v_add_f32_dpp v24, v24, v24 row_ror:1 row_mask:0xf bank_mask:0xf
    v_add_f32_dpp v25, v25, v25 row_ror:1 row_mask:0xf bank_mask:0xf
    s_nop 0
    v_add_f32_dpp v24, v24, v24 row_ror:2 row_mask:0xf bank_mask:0xf
    v_add_f32_dpp v25, v25, v25 row_ror:2 row_mask:0xf bank_mask:0xf
    s_nop 0
    v_add_f32_dpp v24, v24, v24 row_ror:4 row_mask:0xf bank_mask:0xf
    v_add_f32_dpp v25, v25, v25 row_ror:4 row_mask:0xf bank_mask:0xf
    s_nop 0
    v_add_f32_dpp v24, v24, v24 row_ror:8 row_mask:0xf bank_mask:0xf
    v_add_f32_dpp v25, v25, v25 row_ror:8 row_mask:0xf bank_mask:0xf
    s_nop 0
    v_mov_b32 v26, v24
    v_mov_b32 v27, v25
    s_nop 0
    v_permlane32_swap_b32 v24, v26
    v_permlane32_swap_b32 v25, v27
    v_add_f32 v24, v24, v26
    v_add_f32 v25, v25, v27
    v_mov_b32 v26, v24
    v_mov_b32 v27, v25
    s_nop 0
    v_permlane16_swap_b32 v24, v26
    v_permlane16_swap_b32 v25, v27
    v_add_f32 v24, v24, v26
    v_add_f32 v25, v25, v27
    v_mul_f32 v24, 0xbb000000, v24
    v_mul_f32 v25, 0x3b000000, v25
    v_fma_f32 v25, -v24, v24, v25
    v_max_f32 v25, 0, v25
    v_add_f32 v25, 0x3727c5ac, v25
    v_rsq_f32 v25, v25
    v_add_f32 v26, v24, v108
    v_add_f32 v27, v24, v109
    v_mul_f32 v25, 0x3e0293ee, v25
    v_mul_f32 v26, v26, v25
    v_mul_f32 v27, v27, v25
    v_cvt_pk_bf16_f32 v110, v26, v27
    ds_write_b32 v112, v110
    s_barrier
    ds_read_b64_tr_b16 a[64:65], v10 offset:8192
    ds_read_b64_tr_b16 a[66:67], v11 offset:8192
    ds_read_b64_tr_b16 a[68:69], v10 offset:12288
    ds_read_b64_tr_b16 a[70:71], v11 offset:12288
    ds_read_b64_tr_b16 a[72:73], v10 offset:16384
    ds_read_b64_tr_b16 a[74:75], v11 offset:16384
    ds_read_b64_tr_b16 a[76:77], v10 offset:20480
    ds_read_b64_tr_b16 a[78:79], v11 offset:20480
    s_branch L_TQ
L_G:
L_Gp:
    buffer_load_dwordx4 v[64:67], v113, s[40:43], s44 offen sc1
    buffer_load_dwordx4 v[68:71], v113, s[40:43], s45 offen sc1
    buffer_load_dwordx4 v[72:75], v113, s[40:43], s46 offen sc1
    buffer_load_dwordx4 v[76:79], v113, s[40:43], s47 offen sc1
    buffer_load_dwordx4 v[80:83], v113, s[40:43], s48 offen sc1
    buffer_load_dwordx4 v[84:87], v113, s[40:43], s49 offen sc1
    buffer_load_dwordx4 v[88:91], v113, s[40:43], s50 offen sc1
    buffer_load_dwordx4 v[92:95], v113, s[40:43], s51 offen sc1
L_G1:
    s_waitcnt vmcnt(6)
    v_pk_add_f32 v[40:41], v[64:65], v[68:69]
    v_pk_add_f32 v[42:43], v[66:67], v[70:71]
    v_max_u32 v44, v64, v68
    s_waitcnt vmcnt(5)
    v_pk_add_f32 v[40:41], v[40:41], v[72:73]
    v_pk_add_f32 v[42:43], v[42:43], v[74:75]
    v_max_u32 v44, v44, v72
    s_waitcnt vmcnt(4)
    v_pk_add_f32 v[40:41], v[40:41], v[76:77]
    v_pk_add_f32 v[42:43], v[42:43], v[78:79]
    v_max_u32 v44, v44, v76
    s_waitcnt vmcnt(3)
    v_pk_add_f32 v[40:41], v[40:41], v[80:81]
    v_pk_add_f32 v[42:43], v[42:43], v[82:83]
    v_max_u32 v44, v44, v80
    s_waitcnt vmcnt(2)
    v_pk_add_f32 v[40:41], v[40:41], v[84:85]
    v_pk_add_f32 v[42:43], v[42:43], v[86:87]
    v_max_u32 v44, v44, v84
    s_waitcnt vmcnt(1)
    v_pk_add_f32 v[40:41], v[40:41], v[88:89]
    v_pk_add_f32 v[42:43], v[42:43], v[90:91]
    v_max_u32 v44, v44, v88
    s_waitcnt vmcnt(0)
    v_pk_add_f32 v[40:41], v[40:41], v[92:93]
    v_pk_add_f32 v[42:43], v[42:43], v[94:95]
    v_max_u32 v44, v44, v92
    v_cmp_eq_u32 vcc, -1, v44
    v_permlane32_swap_b32 v40, v42
    v_permlane32_swap_b32 v41, v43
    v_add_f32 v40, v40, v42
    v_add_f32 v41, v41, v43
    v_add_f32 v40, v40, v108
    v_add_f32 v41, v41, v109
    v_cvt_pk_bf16_f32 v110, v40, v41
    ds_write_b32 v112, v110
    s_cbranch_vccnz L_Gretry
L_Gok:
    v_lshlrev_b32 v108, 16, v110
    v_and_b32 v109, 0xffff0000, v110
    s_cmp_eq_u32 s62, 1
    s_cbranch_scc1 L_TU
    s_cmp_eq_u32 s62, 0
    s_cbranch_scc0 L_Gother
L_TQ:
    s_cmp_lg_u32 s30, 0
    s_waitcnt lgkmcnt(0)
    s_barrier
    ds_read_b128 v[8:11], v111 offset:0
    ds_read_b128 v[12:15], v111 offset:64
    ds_read_b128 v[16:19], v111 offset:128
    ds_read_b128 v[20:23], v111 offset:192
    s_cbranch_scc1 L_TQw
    v_dot2_f32_bf16 v46, v110, v110, 0
    v_dot2_f32_bf16 v47, v110, v57, 0
    s_nop 2
    v_permlane32_swap_b32 v47, v46
    v_add_f32 v46, v46, v47
    s_nop 1
    v_add_f32_dpp v46, v46, v46 row_ror:1 row_mask:0xf bank_mask:0xf
    s_nop 1
    v_add_f32_dpp v46, v46, v46 row_ror:2 row_mask:0xf bank_mask:0xf
    s_waitcnt lgkmcnt(3)
    v_mfma_f32_16x16x32_bf16 v[24:27], a[64:67], v[8:11], 0
    v_add_f32_dpp v46, v46, v46 row_ror:4 row_mask:0xf bank_mask:0xf
    s_waitcnt lgkmcnt(2)
    v_mfma_f32_16x16x32_bf16 v[24:27], a[68:71], v[12:15], v[24:27]
    v_add_f32_dpp v46, v46, v46 row_ror:8 row_mask:0xf bank_mask:0xf
    s_waitcnt lgkmcnt(1)
    v_mfma_f32_16x16x32_bf16 v[24:27], a[72:75], v[16:19], v[24:27]
    v_add_f32_dpp v46, v46, v46 row_bcast:15 row_mask:0xa bank_mask:0xf
    s_waitcnt lgkmcnt(0)
    v_mfma_f32_16x16x32_bf16 v[24:27], a[76:79], v[20:23], v[24:27]
    v_mov_b32 v52, v46
    v_mov_b32_dpp v53, v46 row_bcast:31 row_mask:0xc bank_mask:0xf
    s_cmp_eq_u32 s15, 0
    s_cbranch_scc0 L_TQalt
    s_mov_b64 exec, s[70:71]
    s_nop 2
    buffer_store_dwordx4 v[24:27], v114, s[36:39], 0 offen
    s_mov_b64 exec, s[78:79]
    buffer_store_dwordx2 v[52:53], v116, s[36:39], 0 offen
    s_mov_b64 exec, -1
L_QFe:
    s_movk_i32 s63, 4096
L_QFp:
    buffer_load_dwordx2 v[48:49], v115, s[36:39], 0 offen sc1
    buffer_load_dwordx4 v[64:67], v141, s[36:39], 0 offen offset:0 sc1
    buffer_load_dwordx4 v[68:71], v141, s[36:39], 0 offen offset:2048 sc1
    buffer_load_dwordx4 v[72:75], v141, s[36:39], s63 offen offset:0 sc1
    buffer_load_dwordx4 v[76:79], v141, s[36:39], s63 offen offset:2048 sc1
    buffer_load_dwordx4 v[80:83], v141, s[36:39], 0 offen offset:1024 sc1
    buffer_load_dwordx4 v[84:87], v141, s[36:39], 0 offen offset:3072 sc1
    buffer_load_dwordx4 v[88:91], v141, s[36:39], s63 offen offset:1024 sc1
    buffer_load_dwordx4 v[92:95], v141, s[36:39], s63 offen offset:3072 sc1
    s_waitcnt vmcnt(8)
    v_cmp_eq_u32 vcc, -1, v48
    v_add_f32_dpp v38, v48, v48 quad_perm:[1,0,3,2] row_mask:0xf bank_mask:0xf
    v_add_f32_dpp v39, v49, v49 quad_perm:[1,0,3,2] row_mask:0xf bank_mask:0xf
    s_cbranch_vccnz L_QFretry
L_QF2:
    v_add_f32_dpp v38, v38, v38 quad_perm:[2,3,0,1] row_mask:0xf bank_mask:0xf
    v_add_f32_dpp v39, v39, v39 quad_perm:[2,3,0,1] row_mask:0xf bank_mask:0xf
    v_mul_f32 v38, 0x3b000000, v38
    v_mul_f32 v46, 0xbb000000, v39
    v_fma_f32 v38, -v46, v46, v38
    v_max_f32 v38, 0, v38
    v_add_f32 v38, 0x3727c5ac, v38
    v_rsq_f32 v38, v38
    s_waitcnt vmcnt(6)
    v_pk_add_f32 v[40:41], v[64:65], v[68:69]
    v_pk_add_f32 v[42:43], v[66:67], v[70:71]
    v_mul_f32 v38, 0x3e0293ee, v38
    s_waitcnt vmcnt(5)
    v_pk_add_f32 v[40:41], v[40:41], v[72:73]
    v_pk_add_f32 v[42:43], v[42:43], v[74:75]
    v_max3_u32 v44, v64, v68, v72
    v_pk_fma_f32 v[40:41], v[96:97], v[46:47], v[40:41] op_sel_hi:[1,0,1]
    v_pk_fma_f32 v[42:43], v[98:99], v[46:47], v[42:43] op_sel_hi:[1,0,1]
    s_waitcnt vmcnt(3)
    v_pk_add_f32 v[40:41], v[40:41], v[76:77]
    v_pk_add_f32 v[42:43], v[42:43], v[78:79]
    v_max3_u32 v44, v44, v76, v80
    v_pk_fma_f32 v[24:25], v[100:101], v[46:47], v[80:81] op_sel_hi:[1,0,1]
    v_pk_fma_f32 v[26:27], v[102:103], v[46:47], v[82:83] op_sel_hi:[1,0,1]
    v_pk_mul_f32 v[40:41], v[40:41], v[38:39] op_sel_hi:[1,0]
    v_pk_mul_f32 v[42:43], v[42:43], v[38:39] op_sel_hi:[1,0]
    s_waitcnt vmcnt(2)
    v_pk_add_f32 v[24:25], v[24:25], v[84:85]
    v_pk_add_f32 v[26:27], v[26:27], v[86:87]
    v_cvt_pk_bf16_f32 v40, v40, v41
    v_cvt_pk_bf16_f32 v41, v42, v43
    s_waitcnt vmcnt(1)
    v_pk_add_f32 v[24:25], v[24:25], v[88:89]
    v_pk_add_f32 v[26:27], v[26:27], v[90:91]
    ds_write_b64 v139, v[40:41] offset:1280
    v_max3_u32 v44, v44, v84, v88
    s_waitcnt vmcnt(0)
    v_pk_add_f32 v[24:25], v[24:25], v[92:93]
    v_pk_add_f32 v[26:27], v[26:27], v[94:95]
    v_pk_mul_f32 v[24:25], v[24:25], v[38:39] op_sel_hi:[1,0]
    v_pk_mul_f32 v[26:27], v[26:27], v[38:39] op_sel_hi:[1,0]
    v_cvt_pk_bf16_f32 v24, v24, v25
    v_cvt_pk_bf16_f32 v25, v26, v27
    ds_write_b64 v139, v[24:25] offset:1920
    v_max_u32 v44, v44, v92
    v_cmp_eq_u32 vcc, -1, v44
    s_cbranch_vccnz L_QF2retry
L_S:
    s_mov_b64 exec, -1
    s_waitcnt lgkmcnt(0)
    s_barrier
    ds_read_b128 v[8:11], v129 offset:1280
    ds_read_b128 v[12:15], v129 offset:1344
    ds_read_b128 v[16:19], v129 offset:1408
    ds_read_b128 v[20:23], v129 offset:1472
    s_waitcnt lgkmcnt(3)
    v_mfma_f32_16x16x32_bf16 v[24:27], a[0:3], v[8:11], 0
    v_mfma_f32_16x16x32_bf16 v[28:31], a[16:19], v[8:11], 0
    s_waitcnt lgkmcnt(2)
    v_mfma_f32_16x16x32_bf16 v[24:27], a[4:7], v[12:15], v[24:27]
    v_mfma_f32_16x16x32_bf16 v[28:31], a[20:23], v[12:15], v[28:31]
    s_waitcnt lgkmcnt(1)
    v_mfma_f32_16x16x32_bf16 v[24:27], a[8:11], v[16:19], v[24:27]
    v_mfma_f32_16x16x32_bf16 v[28:31], a[24:27], v[16:19], v[28:31]
    s_waitcnt lgkmcnt(0)
    v_mfma_f32_16x16x32_bf16 v[24:27], a[12:15], v[20:23], v[24:27]
    v_mfma_f32_16x16x32_bf16 v[28:31], a[28:31], v[20:23], v[28:31]
    v_mov_b32 v32, 0
    s_nop 5
    v_exp_f32 v40, v24
    v_exp_f32 v41, v25
    v_exp_f32 v42, v26
    v_exp_f32 v43, v27
    v_exp_f32 v44, v28
    v_exp_f32 v45, v29
    v_exp_f32 v46, v30
    v_exp_f32 v47, v31
    v_cvt_pk_bf16_f32 v36, v40, v41
    v_cvt_pk_bf16_f32 v37, v42, v43
    v_cvt_pk_bf16_f32 v38, v44, v45
    v_cvt_pk_bf16_f32 v39, v46, v47
    s_mov_b64 exec, s[66:67]
    ds_write_b128 v131, v[36:39] offset:2560
    v_dot2_f32_bf16 v33, v36, v57, 0
    v_dot2_f32_bf16 v33, v37, v57, v33
    v_dot2_f32_bf16 v33, v38, v57, v33
    v_dot2_f32_bf16 v33, v39, v57, v33
    v_max3_f32 v34, v24, v25, v26
    v_max3_f32 v35, v27, v28, v29
    v_max3_f32 v34, v34, v30, v31
    ds_write_b64 v132, v[32:33] offset:3584
    v_max_f32 v34, v34, v35
    v_cmp_nle_f32 vcc, |v34|, s3
    s_cbranch_vccnz L_Sbig
L_Sp:
    s_mov_b64 exec, -1
    s_cmp_eq_u32 s14, 0
    s_waitcnt lgkmcnt(0)
    s_barrier
    ds_read_b128 v[8:11], v130 offset:2560
    ds_read_b128 v[12:15], v130 offset:2816
    ds_read_b128 v[16:19], v130 offset:3072
    ds_read_b128 v[20:23], v130 offset:3328
    ds_read_b64 v[32:33], v133 offset:3584
    s_waitcnt lgkmcnt(4)
    v_mfma_f32_16x16x32_bf16 v[24:27], v[8:11], a[32:35], 0
    v_mfma_f32_16x16x32_bf16 v[28:31], v[8:11], a[36:39], 0
    s_waitcnt lgkmcnt(3)
    v_mfma_f32_16x16x32_bf16 v[24:27], v[12:15], a[40:43], v[24:27]
    v_mfma_f32_16x16x32_bf16 v[28:31], v[12:15], a[44:47], v[28:31]
    s_waitcnt lgkmcnt(2)
    v_mfma_f32_16x16x32_bf16 v[24:27], v[16:19], a[48:51], v[24:27]
    v_mfma_f32_16x16x32_bf16 v[28:31], v[16:19], a[52:55], v[28:31]
    s_waitcnt lgkmcnt(1)
    v_mfma_f32_16x16x32_bf16 v[24:27], v[20:23], a[56:59], v[24:27]
    v_mfma_f32_16x16x32_bf16 v[28:31], v[20:23], a[60:63], v[28:31]
    s_waitcnt lgkmcnt(0)
    v_add_f32_dpp v35, v33, v33 row_ror:1 row_mask:0xf bank_mask:0xf
    v_cmp_neq_f32 vcc, 0, v32
    v_mov_b32 v34, 0
    v_add_f32_dpp v35, v35, v35 row_ror:2 row_mask:0xf bank_mask:0xf
    s_cbranch_vccnz L_PVbig
    s_nop 0
    v_add_f32_dpp v35, v35, v35 row_ror:4 row_mask:0xf bank_mask:0xf
    v_cvt_pk_bf16_f32 v36, v24, v28
    s_nop 0
    v_add_f32_dpp v35, v35, v35 row_ror:8 row_mask:0xf bank_mask:0xf
L_PVt:
    v_mov_b32_dpp v37, v36 quad_perm:[1,1,1,1] row_mask:0xf bank_mask:0xf
    v_mov_b32_dpp v38, v36 quad_perm:[2,2,2,2] row_mask:0xf bank_mask:0xf
    v_mov_b32_dpp v39, v36 quad_perm:[3,3,3,3] row_mask:0xf bank_mask:0xf
    s_mov_b64 exec, s[66:67]
    s_cbranch_scc0 L_RECsafe
    buffer_store_dwordx4 v[36:39], v117, s[36:39], 0 offen
    s_mov_b64 exec, s[68:69]
    buffer_store_dwordx2 v[34:35], v118, s[36:39], 0 offen
L_RECd:
    s_mov_b64 exec, -1
    s_cmp_ge_u32 s29, 16
    s_cbranch_scc1 L_B
    s_cmp_eq_u32 s34, 0
    s_cbranch_scc0 L_O
    s_waitcnt vmcnt(2)
    s_barrier
    v_xor_b32 v6, 0, v140
    v_xor_b32 v7, 32, v6
    v_add_u32 v7, 256, v7
    ds_read_b64_tr_b16 a[80:81], v6 offset:0
    ds_read_b64_tr_b16 a[82:83], v7 offset:0
    ds_read_b64_tr_b16 a[84:85], v6 offset:4096
    ds_read_b64_tr_b16 a[86:87], v7 offset:4096
    ds_read_b64_tr_b16 a[88:89], v6 offset:8192
    ds_read_b64_tr_b16 a[90:91], v7 offset:8192
    ds_read_b64_tr_b16 a[92:93], v6 offset:12288
    ds_read_b64_tr_b16 a[94:95], v7 offset:12288
    v_xor_b32 v6, 32, v140
    v_xor_b32 v7, 32, v6
    v_add_u32 v7, 256, v7
    ds_read_b64_tr_b16 a[96:97], v6 offset:0
    ds_read_b64_tr_b16 a[98:99], v7 offset:0
    ds_read_b64_tr_b16 a[100:101], v6 offset:4096
    ds_read_b64_tr_b16 a[102:103], v7 offset:4096
    ds_read_b64_tr_b16 a[104:105], v6 offset:8192
    ds_read_b64_tr_b16 a[106:107], v7 offset:8192
    ds_read_b64_tr_b16 a[108:109], v6 offset:12288
    ds_read_b64_tr_b16 a[110:111], v7 offset:12288
    v_xor_b32 v6, 64, v140
    v_xor_b32 v7, 32, v6
    v_add_u32 v7, 256, v7
    ds_read_b64_tr_b16 a[112:113], v6 offset:0
    ds_read_b64_tr_b16 a[114:115], v7 offset:0
    ds_read_b64_tr_b16 a[116:117], v6 offset:4096
    ds_read_b64_tr_b16 a[118:119], v7 offset:4096
    ds_read_b64_tr_b16 a[120:121], v6 offset:8192
    ds_read_b64_tr_b16 a[122:123], v7 offset:8192
    ds_read_b64_tr_b16 a[124:125], v6 offset:12288
    ds_read_b64_tr_b16 a[126:127], v7 offset:12288
    v_xor_b32 v6, 96, v140
    v_xor_b32 v7, 32, v6
    v_add_u32 v7, 256, v7
    ds_read_b64_tr_b16 a[128:129], v6 offset:0
    ds_read_b64_tr_b16 a[130:131], v7 offset:0
    ds_read_b64_tr_b16 a[132:133], v6 offset:4096
    ds_read_b64_tr_b16 a[134:135], v7 offset:4096
    ds_read_b64_tr_b16 a[136:137], v6 offset:8192
    ds_read_b64_tr_b16 a[138:139], v7 offset:8192
    ds_read_b64_tr_b16 a[140:141], v6 offset:12288
    ds_read_b64_tr_b16 a[142:143], v7 offset:12288
L_O:
    s_waitcnt vmcnt(0)
L_Op:
    buffer_load_dwordx2 v[4:5], v120, s[36:39], 0 offen sc1
    buffer_load_dwordx4 v[8:11], v119, s[36:39], 0 offen offset:0 sc1
    s_nop 5
    buffer_load_dwordx4 v[12:15], v119, s[36:39], 0 offen offset:1024 sc1
    s_nop 5
    buffer_load_dwordx4 v[16:19], v119, s[36:39], 0 offen offset:2048 sc1
    s_nop 5
    buffer_load_dwordx4 v[20:23], v119, s[36:39], 0 offen offset:3072 sc1
L_O1:
    s_waitcnt vmcnt(4) lgkmcnt(0)
    v_cmp_eq_u32 vcc, -1, v5
    s_cbranch_vccnz L_Oretry
L_O2:
    s_waitcnt vmcnt(3)
    v_mfma_f32_16x16x32_bf16 v[24:27], v[8:11], a[80:83], 0
    v_mfma_f32_16x16x32_bf16 v[28:31], v[8:11], a[96:99], 0
    v_mfma_f32_16x16x32_bf16 v[32:35], v[8:11], a[112:115], 0
    v_mfma_f32_16x16x32_bf16 v[36:39], v[8:11], a[128:131], 0
    s_waitcnt vmcnt(2)
    v_mfma_f32_16x16x32_bf16 v[24:27], v[12:15], a[84:87], v[24:27]
    v_mfma_f32_16x16x32_bf16 v[28:31], v[12:15], a[100:103], v[28:31]
    v_mfma_f32_16x16x32_bf16 v[32:35], v[12:15], a[116:119], v[32:35]
    v_mfma_f32_16x16x32_bf16 v[36:39], v[12:15], a[132:135], v[36:39]
    s_waitcnt vmcnt(1)
    v_mfma_f32_16x16x32_bf16 v[24:27], v[16:19], a[88:91], v[24:27]
    v_add_f32_dpp v6, v5, v5 quad_perm:[1,0,3,2] row_mask:0xf bank_mask:0xf
    v_max3_u32 v44, v8, v12, v16
    v_mfma_f32_16x16x32_bf16 v[28:31], v[16:19], a[104:107], v[28:31]
    v_add_f32_dpp v6, v6, v6 quad_perm:[2,3,0,1] row_mask:0xf bank_mask:0xf
    v_cmp_neq_f32 s[74:75], 0, v4
    v_mfma_f32_16x16x32_bf16 v[32:35], v[16:19], a[120:123], v[32:35]
    v_add_f32_dpp v6, v6, v6 row_half_mirror row_mask:0xf bank_mask:0xf
    v_mov_b32 v7, v6
    v_mfma_f32_16x16x32_bf16 v[36:39], v[16:19], a[136:139], v[36:39]
    s_waitcnt vmcnt(0)
    v_permlane32_swap_b32 v6, v7
    v_mfma_f32_16x16x32_bf16 v[24:27], v[20:23], a[92:95], v[24:27]
    v_add_f32 v6, v6, v7
    v_mov_b32 v7, v6
    v_mfma_f32_16x16x32_bf16 v[28:31], v[20:23], a[108:111], v[28:31]
    v_max_u32 v44, v44, v20
    v_permlane16_swap_b32 v6, v7
    v_mfma_f32_16x16x32_bf16 v[32:35], v[20:23], a[124:127], v[32:35]
    v_cmp_eq_u32 vcc, -1, v44
    v_add_f32 v6, v6, v7
    v_mfma_f32_16x16x32_bf16 v[36:39], v[20:23], a[140:143], v[36:39]
    v_rcp_f32 v6, v6
    s_cbranch_vccnz L_O2retry
L_Ook:
    s_cmp_lg_u64 s[74:75], 0
    s_cbranch_scc1 L_Obig
    v_pk_add_f32 v[24:25], v[24:25], v[26:27]
    v_pk_add_f32 v[28:29], v[28:29], v[30:31]
    v_add_f32 v40, v24, v25
    v_add_f32 v41, v28, v29
    v_pk_add_f32 v[32:33], v[32:33], v[34:35]
    v_pk_add_f32 v[36:37], v[36:37], v[38:39]
    v_add_f32 v42, v32, v33
    v_add_f32 v43, v36, v37
L_Ot:
    v_permlane32_swap_b32 v40, v41
    v_add_f32 v40, v40, v41
    v_permlane32_swap_b32 v42, v43
    v_add_f32 v42, v42, v43
    s_add_u32 s63, s35, 106496
    s_cmp_eq_u32 s30, 0
    v_permlane16_swap_b32 v40, v42
    v_add_f32 v40, v40, v42
    v_mul_f32 v40, v40, v6
    ds_write_b32 v134, v40 offset:4096
    s_waitcnt lgkmcnt(0)
    s_barrier
    s_cbranch_scc0 L_Odone
    s_mov_b64 exec, 0xffff
    ds_read_b128 v[8:11], v127 offset:4096
    ds_read_b128 v[12:15], v127 offset:4352
    ds_read_b128 v[16:19], v127 offset:4608
    ds_read_b128 v[20:23], v127 offset:4864
    s_waitcnt lgkmcnt(2)
    v_pk_add_f32 v[8:9], v[8:9], v[12:13]
    v_pk_add_f32 v[10:11], v[10:11], v[14:15]
    s_waitcnt lgkmcnt(1)
    v_pk_add_f32 v[8:9], v[8:9], v[16:17]
    v_pk_add_f32 v[10:11], v[10:11], v[18:19]
    s_waitcnt lgkmcnt(0)
    v_pk_add_f32 v[8:9], v[8:9], v[20:21]
    v_pk_add_f32 v[10:11], v[10:11], v[22:23]
    buffer_store_dwordx4 v[8:11], v127, s[36:39], s63 offen sc1
    s_mov_b64 exec, -1
L_Odone:
    s_cmp_eq_u32 s30, 0
    s_cbranch_scc0 L_Aside
    s_cmp_eq_u32 s34, 0
    s_cbranch_scc0 L_Dq
    s_lshr_b32 s63, s28, 1
    s_mul_i32 s63, s63, 7
    s_and_b32 s64, s28, 1
    s_lshl_b32 s74, s64, 2
    s_add_u32 s63, s63, s74
    s_lshr_b32 s74, s33, 3
    s_and_b32 s64, s64, s74
    s_lshl_b32 s74, s74, 1
    s_add_u32 s63, s63, s74
    s_lshl_b32 s63, s63, 16
    s_and_b32 s74, s33, 7
    s_lshl_b32 s74, s74, 1
    s_add_u32 s74, s74, s30
    s_lshl_b32 s74, s74, 6
    s_add_u32 s63, s63, s74
    s_add_u32 s20, s20, s63
    s_addc_u32 s21, s21, 0
    s_lshl_b32 s64, s64, 16
    s_lshl_b32 s63, s30, 13
    s_add_u32 m0, s63, 8192
    v_bfe_u32 v4, v0, 2, 4
    v_and_b32 v5, 32, v0
    v_and_b32 v6, 48, v127
    v_xor_b32 v5, v5, v6
    v_lshl_add_u32 v4, v4, 10, v5
    global_load_lds_dwordx4 v4, s[20:21] nt
    s_add_u32 m0, m0, 1024
    v_add_u32 v4, 0x4000, v4
    global_load_lds_dwordx4 v4, s[20:21] nt
    s_add_u32 m0, m0, 1024
    v_add_u32 v4, 0x4000, v4
    global_load_lds_dwordx4 v4, s[20:21] nt
    s_add_u32 m0, m0, 1024
    v_add_u32 v4, 0x4000, v4
    global_load_lds_dwordx4 v4, s[20:21] nt
    s_add_u32 m0, m0, 1024
    v_add_u32 v4, 0x4000, v4
    v_subrev_u32 v4, s64, v4
    global_load_lds_dwordx4 v4, s[20:21] nt
    s_add_u32 m0, m0, 1024
    v_add_u32 v4, 0x4000, v4
    global_load_lds_dwordx4 v4, s[20:21] nt
    s_add_u32 m0, m0, 1024
    v_add_u32 v4, 0x4000, v4
    global_load_lds_dwordx4 v4, s[20:21] nt
    s_add_u32 m0, m0, 1024
    v_add_u32 v4, 0x4000, v4
    global_load_lds_dwordx4 v4, s[20:21] nt
    v_bfe_u32 v4, v0, 2, 2
    v_bfe_u32 v5, v0, 4, 2
    v_lshl_add_u32 v4, v5, 3, v4
    v_lshlrev_b32 v4, 6, v4
    v_and_b32 v5, 1, v5
    v_lshl_add_u32 v4, v5, 5, v4
    v_and_b32 v5, 3, v0
    v_lshl_add_u32 v4, v5, 3, v4
    v_add_u32 v6, s63, v4
    v_xor_b32 v7, 32, v6
    s_waitcnt vmcnt(0)
    ds_read_b64_tr_b16 a[144:145], v6 offset:8192
    ds_read_b64_tr_b16 a[146:147], v6 offset:8448
    ds_read_b64_tr_b16 a[148:149], v6 offset:10240
    ds_read_b64_tr_b16 a[150:151], v6 offset:10496
    ds_read_b64_tr_b16 a[152:153], v6 offset:12288
    ds_read_b64_tr_b16 a[154:155], v6 offset:12544
    ds_read_b64_tr_b16 a[156:157], v6 offset:14336
    ds_read_b64_tr_b16 a[158:159], v6 offset:14592
    ds_read_b64_tr_b16 a[160:161], v7 offset:8192
    ds_read_b64_tr_b16 a[162:163], v7 offset:8448
    ds_read_b64_tr_b16 a[164:165], v7 offset:10240
    ds_read_b64_tr_b16 a[166:167], v7 offset:10496
    ds_read_b64_tr_b16 a[168:169], v7 offset:12288
    ds_read_b64_tr_b16 a[170:171], v7 offset:12544
    ds_read_b64_tr_b16 a[172:173], v7 offset:14336
    ds_read_b64_tr_b16 a[174:175], v7 offset:14592
    s_mov_b32 s63, 52224
L_HC:
    buffer_load_dwordx4 v[8:11], v121, s[36:39], s63 offen offset:0 sc1
    buffer_load_dwordx4 v[12:15], v121, s[36:39], s63 offen offset:1024 sc1
    buffer_load_dwordx4 v[16:19], v121, s[36:39], s63 offen offset:2048 sc1
    buffer_load_dwordx4 v[20:23], v121, s[36:39], s63 offen offset:3072 sc1
    s_waitcnt vmcnt(0)
    v_max3_u32 v44, v8, v12, v16
    v_max_u32 v44, v44, v20
    v_cmp_eq_u32 vcc, -1, v44
    v_pk_add_f32 v[8:9], v[8:9], v[12:13]
    v_pk_add_f32 v[10:11], v[10:11], v[14:15]
    v_pk_add_f32 v[16:17], v[16:17], v[20:21]
    v_pk_add_f32 v[18:19], v[18:19], v[22:23]
    v_pk_add_f32 v[104:105], v[8:9], v[16:17]
    v_pk_add_f32 v[106:107], v[10:11], v[18:19]
    s_cbranch_vccz L_Dp0
    s_sub_u32 s61, s61, 1
    s_cbranch_scc0 L_HC
    s_mov_b32 s61, 0
    s_branch L_Dp
L_Dq:
    s_lshl_b32 s64, s33, 4
    s_add_u32 s64, s64, 42496
    v_mov_b32 v1, 0
    s_mov_b64 exec, 1
    s_cmp_eq_u32 s14, 0
    s_waitcnt vmcnt(0)
    s_cbranch_scc0 BR_1
    buffer_store_dword v1, v1, s[36:39], s64 offen
BR_2:
    s_mov_b64 exec, -1
L_Dp0:
L_Dp:
    buffer_load_dwordx2 v[48:49], v137, s[36:39], 0 offen sc1
    buffer_load_dwordx4 v[64:67], v121, s[36:39], 0 offen offset:0 sc1
    buffer_load_dwordx4 v[68:71], v121, s[36:39], 0 offen offset:1024 sc1
    buffer_load_dwordx4 v[72:75], v121, s[36:39], 0 offen offset:2048 sc1
    buffer_load_dwordx4 v[76:79], v121, s[36:39], 0 offen offset:3072 sc1
L_DpB:
    buffer_load_dwordx2 v[50:51], v137, s[36:39], 0 offen sc1
    buffer_load_dwordx4 v[80:83], v121, s[36:39], 0 offen offset:0 sc1
    buffer_load_dwordx4 v[84:87], v121, s[36:39], 0 offen offset:1024 sc1
    buffer_load_dwordx4 v[88:91], v121, s[36:39], 0 offen offset:2048 sc1
    buffer_load_dwordx4 v[92:95], v121, s[36:39], 0 offen offset:3072 sc1
    s_waitcnt vmcnt(9)
    v_cmp_eq_u32 vcc, -1, v48
    v_add_f32_dpp v46, v48, v48 quad_perm:[1,0,3,2] row_mask:0xf bank_mask:0xf
    v_add_f32_dpp v47, v49, v49 quad_perm:[1,0,3,2] row_mask:0xf bank_mask:0xf
    s_cbranch_vccnz L_Dretry
L_D2:
    v_add_f32_dpp v46, v46, v46 quad_perm:[2,3,0,1] row_mask:0xf bank_mask:0xf
    v_add_f32_dpp v47, v47, v47 quad_perm:[2,3,0,1] row_mask:0xf bank_mask:0xf
    v_mul_f32 v45, 0x3b000000, v46
    v_mul_f32 v46, 0xbb000000, v47
    v_fma_f32 v45, -v46, v46, v45
    v_max_f32 v45, 0, v45
    v_add_f32 v45, 0x3727c5ac, v45
    v_rcp_f32 v45, v45
    s_waitcnt vmcnt(7)
    v_max_u32 v44, v64, v68
    v_pk_fma_f32 v[40:41], v[104:105], v[46:47], v[64:65] op_sel_hi:[1,0,1]
    v_pk_fma_f32 v[42:43], v[106:107], v[46:47], v[66:67] op_sel_hi:[1,0,1]
    v_pk_add_f32 v[40:41], v[40:41], v[68:69]
    v_pk_add_f32 v[42:43], v[42:43], v[70:71]
    s_waitcnt vmcnt(6)
    v_pk_add_f32 v[40:41], v[40:41], v[72:73]
    v_pk_add_f32 v[42:43], v[42:43], v[74:75]
    v_max_u32 v44, v44, v72
    s_waitcnt vmcnt(5)
    v_pk_add_f32 v[40:41], v[40:41], v[76:77]
    v_pk_add_f32 v[42:43], v[42:43], v[78:79]
    v_max_u32 v44, v44, v76
    v_cmp_eq_u32 vcc, -1, v44
    v_permlane32_swap_b32 v40, v42
    v_permlane32_swap_b32 v41, v43
    v_mul_f32 v40, v40, v45
    v_mul_f32 v41, v41, v45
    v_mul_f32 v40, v40, v42
    v_mul_f32 v41, v41, v43
    v_cvt_pk_bf16_f32 v40, v40, v41
    ds_write_b32 v136, v40 offset:1024
    s_cbranch_vccnz L_Dretry
L_Dm:
    s_add_u32 s63, s35, 111616
    s_cmp_ge_u32 s30, 2
    s_waitcnt lgkmcnt(0)
    s_barrier
    s_cbranch_scc1 L_Ddone
    ds_read_b128 v[8:11], v135 offset:1024
    ds_read_b128 v[12:15], v135 offset:1088
    ds_read_b128 v[16:19], v135 offset:1152
    ds_read_b128 v[20:23], v135 offset:1216
    s_waitcnt lgkmcnt(3)
    v_mfma_f32_16x16x32_bf16 v[24:27], a[144:147], v[8:11], 0
    v_mfma_f32_16x16x32_bf16 v[28:31], a[160:163], v[8:11], 0
    s_waitcnt lgkmcnt(2)
    v_mfma_f32_16x16x32_bf16 v[24:27], a[148:151], v[12:15], v[24:27]
    v_mfma_f32_16x16x32_bf16 v[28:31], a[164:167], v[12:15], v[28:31]
    s_waitcnt lgkmcnt(1)
    v_mfma_f32_16x16x32_bf16 v[24:27], a[152:155], v[16:19], v[24:27]
    v_mfma_f32_16x16x32_bf16 v[28:31], a[168:171], v[16:19], v[28:31]
    s_waitcnt lgkmcnt(0)
    v_mfma_f32_16x16x32_bf16 v[24:27], a[156:159], v[20:23], v[24:27]
    v_mfma_f32_16x16x32_bf16 v[28:31], a[172:175], v[20:23], v[28:31]
    s_mov_b64 exec, s[72:73]
    s_nop 6
    v_mov_b32 v24, v28
    v_mov_b32 v25, v29
    v_mov_b32 v26, v30
    v_mov_b32 v27, v31
    s_mov_b32 exec_lo, 0x00030003
    s_mov_b32 exec_hi, 0x00030003
    buffer_store_dwordx4 v[24:27], v138, s[36:39], s63 offen sc1
    s_mov_b64 exec, -1
L_Ddone:
    v_add_u32 v112, 0, v136
    s_mul_i32 s63, s34, 10240
    s_add_u32 s63, s63, 119808
    s_add_u32 s40, s26, s63
    s_addc_u32 s41, s27, 0
    ds_read_b32 v110, v136 offset:512
    s_waitcnt lgkmcnt(0)
    v_lshlrev_b32 v108, 16, v110
    v_and_b32 v109, 0xffff0000, v110
    s_cmp_eq_u32 s34, 0
    s_cbranch_scc1 L_Anext
    s_mov_b32 s62, 3
    s_cmp_eq_u32 s76, 1
    s_cbranch_scc0 L_exit
    s_cmp_eq_u32 s30, 0
    s_cbranch_scc0 L_exit
    s_waitcnt vmcnt(0)
    s_branch L_G
L_Anext:
    s_cmp_eq_u32 s30, 0
    s_cbranch_scc0 L_next
    s_lshl_b32 s64, s33, 4
    s_add_u32 s64, s64, 42752
    v_mov_b32 v1, 0
    s_mov_b64 exec, 1
    s_cmp_eq_u32 s14, 0
    s_waitcnt vmcnt(0)
    s_cbranch_scc0 BR_3
    buffer_store_dword v1, v1, s[36:39], s64 offen
BR_4:
    s_mov_b64 exec, -1
    s_lshl_b32 s64, s33, 4
    s_add_u32 s64, s64, 42752
    v_mov_b32 v1, 0
BW_5:
    buffer_load_dword v2, v1, s[36:39], s64 offen sc1
    s_waitcnt vmcnt(0)
    v_cmp_eq_u32 vcc, -1, v2
    s_cbranch_vccz BW_6
    s_sub_u32 s61, s61, 1
    s_cbranch_scc0 BW_5
    s_mov_b32 s61, 0
    s_branch BW_6
BW_6:
    s_branch L_next
L_Aside:
    s_cmp_eq_u32 s30, 2
    s_cbranch_scc1 L_A2
    s_cmp_eq_u32 s30, 1
    s_cbranch_scc0 L_Dm
    s_cmp_eq_u32 s34, 0
    s_cbranch_scc0 L_Dm
    s_lshr_b32 s63, s28, 1
    s_mul_i32 s63, s63, 7
    s_and_b32 s64, s28, 1
    s_lshl_b32 s74, s64, 2
    s_add_u32 s63, s63, s74
    s_lshr_b32 s74, s33, 3
    s_and_b32 s64, s64, s74
    s_lshl_b32 s74, s74, 1
    s_add_u32 s63, s63, s74
    s_lshl_b32 s63, s63, 16
    s_and_b32 s74, s33, 7
    s_lshl_b32 s74, s74, 1
    s_add_u32 s74, s74, s30
    s_lshl_b32 s74, s74, 6
    s_add_u32 s63, s63, s74
    s_add_u32 s20, s20, s63
    s_addc_u32 s21, s21, 0
    s_lshl_b32 s64, s64, 16
    s_lshl_b32 s63, s30, 13
    s_add_u32 m0, s63, 8192
    v_bfe_u32 v4, v0, 2, 4
    v_and_b32 v5, 32, v0
    v_and_b32 v6, 48, v127
    v_xor_b32 v5, v5, v6
    v_lshl_add_u32 v4, v4, 10, v5
    global_load_lds_dwordx4 v4, s[20:21] nt
    s_add_u32 m0, m0, 1024
    v_add_u32 v4, 0x4000, v4
    global_load_lds_dwordx4 v4, s[20:21] nt
    s_add_u32 m0, m0, 1024
    v_add_u32 v4, 0x4000, v4
    global_load_lds_dwordx4 v4, s[20:21] nt
    s_add_u32 m0, m0, 1024
    v_add_u32 v4, 0x4000, v4
    global_load_lds_dwordx4 v4, s[20:21] nt
    s_add_u32 m0, m0, 1024
    v_add_u32 v4, 0x4000, v4
    v_subrev_u32 v4, s64, v4
    global_load_lds_dwordx4 v4, s[20:21] nt
    s_add_u32 m0, m0, 1024
    v_add_u32 v4, 0x4000, v4
    global_load_lds_dwordx4 v4, s[20:21] nt
    s_add_u32 m0, m0, 1024
    v_add_u32 v4, 0x4000, v4
    global_load_lds_dwordx4 v4, s[20:21] nt
    s_add_u32 m0, m0, 1024
    v_add_u32 v4, 0x4000, v4
    global_load_lds_dwordx4 v4, s[20:21] nt
    v_bfe_u32 v4, v0, 2, 2
    v_bfe_u32 v5, v0, 4, 2
    v_lshl_add_u32 v4, v5, 3, v4
    v_lshlrev_b32 v4, 6, v4
    v_and_b32 v5, 1, v5
    v_lshl_add_u32 v4, v5, 5, v4
    v_and_b32 v5, 3, v0
    v_lshl_add_u32 v4, v5, 3, v4
    v_add_u32 v6, s63, v4
    v_xor_b32 v7, 32, v6
    s_waitcnt vmcnt(0)
    ds_read_b64_tr_b16 a[144:145], v6 offset:8192
    ds_read_b64_tr_b16 a[146:147], v6 offset:8448
    ds_read_b64_tr_b16 a[148:149], v6 offset:10240
    ds_read_b64_tr_b16 a[150:151], v6 offset:10496
    ds_read_b64_tr_b16 a[152:153], v6 offset:12288
    ds_read_b64_tr_b16 a[154:155], v6 offset:12544
    ds_read_b64_tr_b16 a[156:157], v6 offset:14336
    ds_read_b64_tr_b16 a[158:159], v6 offset:14592
    ds_read_b64_tr_b16 a[160:161], v7 offset:8192
    ds_read_b64_tr_b16 a[162:163], v7 offset:8448
    ds_read_b64_tr_b16 a[164:165], v7 offset:10240
    ds_read_b64_tr_b16 a[166:167], v7 offset:10496
    ds_read_b64_tr_b16 a[168:169], v7 offset:12288
    ds_read_b64_tr_b16 a[170:171], v7 offset:12544
    ds_read_b64_tr_b16 a[172:173], v7 offset:14336
    ds_read_b64_tr_b16 a[174:175], v7 offset:14592
    s_branch L_Dm
L_A2:
    s_mov_b32 s62, 2
    s_cmp_eq_u32 s34, 0
    s_cbranch_scc1 L_A20
    s_cmp_eq_u32 s76, 1
    s_cbranch_scc0 L_Dm
    ds_read_b32 v110, v136
    s_waitcnt lgkmcnt(0)
    v_lshlrev_b32 v108, 16, v110
    v_and_b32 v109, 0xffff0000, v110
    s_branch L_A21
L_A20:
    s_mul_i32 s64, s14, 20480
    s_mul_i32 s63, s28, 41984
    s_add_u32 s64, s64, s63
    s_add_u32 s64, s64, 2097152
    s_add_u32 s52, s26, s64
    s_addc_u32 s53, s27, 0
QC_7:
    s_mov_b32 s64, 9216
    buffer_load_dwordx4 v[8:11], v127, s[52:55], s64 offen offset:0 sc1
    buffer_load_dwordx4 v[24:27], v127, s[52:55], s64 offen offset:1024 sc1
    s_mov_b32 s64, 11264
    buffer_load_dwordx4 v[12:15], v127, s[52:55], s64 offen offset:0 sc1
    buffer_load_dwordx4 v[28:31], v127, s[52:55], s64 offen offset:1024 sc1
    s_mov_b32 s64, 13312
    buffer_load_dwordx4 v[16:19], v127, s[52:55], s64 offen offset:0 sc1
    buffer_load_dwordx4 v[32:35], v127, s[52:55], s64 offen offset:1024 sc1
    s_mov_b32 s64, 15360
    buffer_load_dwordx4 v[20:23], v127, s[52:55], s64 offen offset:0 sc1
    buffer_load_dwordx4 v[36:39], v127, s[52:55], s64 offen offset:1024 sc1
    s_waitcnt vmcnt(0)
    v_xor_b32 v8, s57, v8
    v_xor_b32 v9, s58, v9
    v_xor_b32 v10, s59, v10
    v_xor_b32 v11, s60, v11
    v_or3_b32 v44, v8, v9, v10
    v_or_b32 v44, v44, v11
    v_xor_b32 v12, s57, v12
    v_xor_b32 v13, s58, v13
    v_xor_b32 v14, s59, v14
    v_xor_b32 v15, s60, v15
    v_or3_b32 v44, v44, v12, v13
    v_or3_b32 v44, v44, v14, v15
    v_xor_b32 v16, s57, v16
    v_xor_b32 v17, s58, v17
    v_xor_b32 v18, s59, v18
    v_xor_b32 v19, s60, v19
    v_or3_b32 v44, v44, v16, v17
    v_or3_b32 v44, v44, v18, v19
    v_xor_b32 v20, s57, v20
    v_xor_b32 v21, s58, v21
    v_xor_b32 v22, s59, v22
    v_xor_b32 v23, s60, v23
    v_or3_b32 v44, v44, v20, v21
    v_or3_b32 v44, v44, v22, v23
    v_pk_add_f32 v[8:9], v[8:9], v[12:13]
    v_pk_add_f32 v[16:17], v[16:17], v[20:21]
    v_pk_add_f32 v[96:97], v[8:9], v[16:17]
    v_pk_add_f32 v[10:11], v[10:11], v[14:15]
    v_pk_add_f32 v[18:19], v[18:19], v[22:23]
    v_pk_add_f32 v[98:99], v[10:11], v[18:19]
    v_xor_b32 v24, s57, v24
    v_xor_b32 v25, s58, v25
    v_xor_b32 v26, s59, v26
    v_xor_b32 v27, s60, v27
    v_or3_b32 v44, v44, v24, v25
    v_or3_b32 v44, v44, v26, v27
    v_xor_b32 v28, s57, v28
    v_xor_b32 v29, s58, v29
    v_xor_b32 v30, s59, v30
    v_xor_b32 v31, s60, v31
    v_or3_b32 v44, v44, v28, v29
    v_or3_b32 v44, v44, v30, v31
    v_xor_b32 v32, s57, v32
    v_xor_b32 v33, s58, v33
    v_xor_b32 v34, s59, v34
    v_xor_b32 v35, s60, v35
    v_or3_b32 v44, v44, v32, v33
    v_or3_b32 v44, v44, v34, v35
    v_xor_b32 v36, s57, v36
    v_xor_b32 v37, s58, v37
    v_xor_b32 v38, s59, v38
    v_xor_b32 v39, s60, v39
    v_or3_b32 v44, v44, v36, v37
    v_or3_b32 v44, v44, v38, v39
    v_pk_add_f32 v[24:25], v[24:25], v[28:29]
    v_pk_add_f32 v[32:33], v[32:33], v[36:37]
    v_pk_add_f32 v[100:101], v[24:25], v[32:33]
    v_pk_add_f32 v[26:27], v[26:27], v[30:31]
    v_pk_add_f32 v[34:35], v[34:35], v[38:39]
    v_pk_add_f32 v[102:103], v[26:27], v[34:35]
    v_and_b32 v44, 255, v44
    v_cmp_ne_u32 vcc, 0, v44
    s_cbranch_vccz QC_8
    s_sub_u32 s61, s61, 1
    s_cbranch_scc0 QC_7
    s_mov_b32 s61, 0
    s_branch QC_8
QC_8:
    ds_write_b128 v127, v[96:99] offset:6144
    ds_write_b128 v127, v[100:103] offset:7168
    v_and_b32 v1, 7, v0
    v_lshlrev_b32 v1, 7, v1
    v_add_u32 v1, 1024, v1
GD_9:
    global_load_dword v2, v1, s[26:27] sc1
    s_waitcnt vmcnt(0)
    v_cmp_ne_u32 vcc, s56, v2
    s_cbranch_vccz GD_10
    s_sub_u32 s61, s61, 1
    s_cbranch_scc0 GD_9
    s_mov_b32 s61, 0
    s_branch GD_10
GD_10:
L_A21:
    s_cmp_eq_u32 s34, 0
    s_cbranch_scc1 BW_12
    s_lshl_b32 s64, s33, 4
    s_add_u32 s64, s64, 42496
    v_mov_b32 v1, 0
BW_11:
    buffer_load_dword v2, v1, s[36:39], s64 offen sc1
    s_waitcnt vmcnt(0)
    v_cmp_eq_u32 vcc, -1, v2
    s_cbranch_vccz BW_12
    s_sub_u32 s61, s61, 1
    s_cbranch_scc0 BW_11
    s_mov_b32 s61, 0
    s_branch BW_12
BW_12:
    v_add_u32 v112, 512, v136
    s_mul_i32 s63, s34, 10240
    s_add_u32 s63, s63, 114688
    s_add_u32 s40, s26, s63
    s_addc_u32 s41, s27, 0
    s_branch L_G
L_Gother:
    s_cmp_eq_u32 s62, 2
    s_cbranch_scc1 L_Dm
L_final:
    s_lshl_b32 s63, s31, 8
    v_add_u32 v1, s63, v136
    global_store_dword v1, v110, s[22:23]
    s_cmp_eq_u32 s2, 0
    s_cbranch_scc0 L_fin2
    s_add_u32 s63, s65, 1
    v_mov_b32 v1, 0
    v_mov_b32 v2, s63
    s_mov_b64 exec, 1
    global_store_dword v1, v2, s[26:27]
    s_mov_b64 exec, -1
L_fin2:
    s_branch L_exit
L_B:
    s_mov_b32 s62, 1
    s_cmp_eq_u32 s34, 0
    s_cbranch_scc0 L_B1
    s_cmp_eq_u32 s30, 0
    s_cbranch_scc0 L_Bg
    s_waitcnt vmcnt(2)
    v_cmp_ne_u32 vcc, s56, v63
    s_cbranch_vccz L_Bg
    v_and_b32 v1, 7, v0
    v_lshlrev_b32 v1, 7, v1
    v_add_u32 v1, 2048, v1
GD_13:
    global_load_dword v2, v1, s[26:27] sc1
    s_waitcnt vmcnt(0)
    v_cmp_ne_u32 vcc, s56, v2
    s_cbranch_vccz GD_14
    s_sub_u32 s61, s61, 1
    s_cbranch_scc0 GD_13
    s_mov_b32 s61, 0
    s_branch GD_14
GD_14:
L_Bg:
    s_barrier
    s_cmp_eq_u32 s4, 7
    s_cbranch_scc1 L_Bs
    s_lshl_b32 s63, s30, 10
    s_add_u32 m0, s63, 57344
    s_nop 0
    global_load_lds_dwordx4 v140, s[16:17] nt
    s_add_u32 m0, m0, 4096
    s_add_u32 s16, s16, 114688
    s_addc_u32 s17, s17, 0
    global_load_lds_dwordx4 v140, s[16:17] nt
    s_add_u32 m0, m0, 4096
    s_add_u32 s16, s16, 114688
    s_addc_u32 s17, s17, 0
    global_load_lds_dwordx4 v140, s[16:17] nt
    s_add_u32 m0, m0, 4096
    s_add_u32 s16, s16, 114688
    s_addc_u32 s17, s17, 0
    global_load_lds_dwordx4 v140, s[16:17] nt
    s_lshl_b32 s63, s30, 10
    s_add_u32 m0, s63, 73728
    s_nop 0
    global_load_lds_dwordx4 v140, s[18:19] nt
    s_add_u32 m0, m0, 4096
    s_add_u32 s18, s18, 114688
    s_addc_u32 s19, s19, 0
    global_load_lds_dwordx4 v140, s[18:19] nt
    s_add_u32 m0, m0, 4096
    s_add_u32 s18, s18, 114688
    s_addc_u32 s19, s19, 0
    global_load_lds_dwordx4 v140, s[18:19] nt
    s_add_u32 m0, m0, 4096
    s_add_u32 s18, s18, 114688
    s_addc_u32 s19, s19, 0
    global_load_lds_dwordx4 v140, s[18:19] nt
L_Bs:
    s_mov_b32 s70, 0x00010001
    s_mov_b32 s71, 0x00010001
    v_and_b32 v1, 7, v0
    v_lshlrev_b32 v1, 7, v1
    v_add_u32 v1, 1024, v1
    global_load_dword v62, v1, s[26:27] sc1
    s_cmp_eq_u32 s30, 3
    s_cbranch_scc0 L_Bu
    s_lshr_b32 s63, s28, 1
    s_mul_i32 s63, s63, 7
    s_and_b32 s64, s28, 1
    s_lshl_b32 s74, s64, 2
    s_add_u32 s63, s63, s74
    s_lshr_b32 s74, s33, 3
    s_and_b32 s64, s64, s74
    s_lshl_b32 s74, s74, 1
    s_add_u32 s63, s63, s74
    s_lshl_b32 s63, s63, 16
    s_and_b32 s74, s33, 7
    s_lshl_b32 s74, s74, 1
    s_lshl_b32 s74, s74, 6
    s_add_u32 s63, s63, s74
    s_add_u32 s20, s20, s63
    s_addc_u32 s21, s21, 0
    s_lshl_b32 s64, s64, 16
    v_lshlrev_b32 v4, 6, v127
    global_load_dword v60, v4, s[20:21] nt
    v_add_u32 v4, 0x10000, v4
    v_subrev_u32 v4, s64, v4
    global_load_dword v61, v4, s[20:21] nt
    s_waitcnt vmcnt(2)
    s_branch L_Bw
L_Bu:
    s_waitcnt vmcnt(0)
L_Bw:
    s_cmp_eq_u32 s4, 7
    s_cbranch_scc0 L_Bload
    v_accvgpr_write_b32 a80, 0
    v_accvgpr_write_b32 a81, 0
    v_accvgpr_write_b32 a82, 0
    v_accvgpr_write_b32 a83, 0
    v_accvgpr_write_b32 a84, 0
    v_accvgpr_write_b32 a85, 0
    v_accvgpr_write_b32 a86, 0
    v_accvgpr_write_b32 a87, 0
    v_accvgpr_write_b32 a88, 0
    v_accvgpr_write_b32 a89, 0
    v_accvgpr_write_b32 a90, 0
    v_accvgpr_write_b32 a91, 0
    v_accvgpr_write_b32 a92, 0
    v_accvgpr_write_b32 a93, 0
    v_accvgpr_write_b32 a94, 0
    v_accvgpr_write_b32 a95, 0
    v_accvgpr_write_b32 a96, 0
    v_accvgpr_write_b32 a97, 0
    v_accvgpr_write_b32 a98, 0
    v_accvgpr_write_b32 a99, 0
    v_accvgpr_write_b32 a100, 0
    v_accvgpr_write_b32 a101, 0
    v_accvgpr_write_b32 a102, 0
    v_accvgpr_write_b32 a103, 0
    v_accvgpr_write_b32 a104, 0
    v_accvgpr_write_b32 a105, 0
    v_accvgpr_write_b32 a106, 0
    v_accvgpr_write_b32 a107, 0
    v_accvgpr_write_b32 a108, 0
    v_accvgpr_write_b32 a109, 0
    v_accvgpr_write_b32 a110, 0
    v_accvgpr_write_b32 a111, 0
    s_branch L_B0
L_Bload:
    s_lshl_b32 s63, s30, 5
    v_xor_b32 v6, s63, v125
    v_xor_b32 v7, 32, v6
    v_add_u32 v7, 57856, v7
    v_add_u32 v6, 57344, v6
    s_barrier
    ds_read_b64_tr_b16 a[80:81], v6 offset:0
    ds_read_b64_tr_b16 a[82:83], v7 offset:0
    ds_read_b64_tr_b16 a[84:85], v6 offset:4096
    ds_read_b64_tr_b16 a[86:87], v7 offset:4096
    ds_read_b64_tr_b16 a[88:89], v6 offset:8192
    ds_read_b64_tr_b16 a[90:91], v7 offset:8192
    ds_read_b64_tr_b16 a[92:93], v6 offset:12288
    ds_read_b64_tr_b16 a[94:95], v7 offset:12288
    ds_read_b64_tr_b16 a[96:97], v6 offset:16384
    ds_read_b64_tr_b16 a[98:99], v7 offset:16384
    ds_read_b64_tr_b16 a[100:101], v6 offset:20480
    ds_read_b64_tr_b16 a[102:103], v7 offset:20480
    ds_read_b64_tr_b16 a[104:105], v6 offset:24576
    ds_read_b64_tr_b16 a[106:107], v7 offset:24576
    ds_read_b64_tr_b16 a[108:109], v6 offset:28672
    ds_read_b64_tr_b16 a[110:111], v7 offset:28672
L_B0:
    v_mov_b32 v8, v57
    v_mov_b32 v9, v57
    v_mov_b32 v10, v57
    v_mov_b32 v11, v57
    s_waitcnt lgkmcnt(0)
    s_nop 0
    v_mfma_f32_16x16x32_bf16 v[24:27], a[80:83], v[8:11], 0
    v_mfma_f32_16x16x32_bf16 v[28:31], a[96:99], v[8:11], 0
    v_mfma_f32_16x16x32_bf16 v[24:27], a[84:87], v[8:11], v[24:27]
    v_mfma_f32_16x16x32_bf16 v[28:31], a[100:103], v[8:11], v[28:31]
    v_mfma_f32_16x16x32_bf16 v[24:27], a[88:91], v[8:11], v[24:27]
    v_mfma_f32_16x16x32_bf16 v[28:31], a[104:107], v[8:11], v[28:31]
    v_mfma_f32_16x16x32_bf16 v[24:27], a[92:95], v[8:11], v[24:27]
    v_mfma_f32_16x16x32_bf16 v[28:31], a[108:111], v[8:11], v[28:31]
    s_mov_b32 s63, 52224
    s_mov_b64 exec, s[70:71]
    s_cmp_eq_u32 s14, 0
    s_cbranch_scc0 L_B0s
    s_nop 3
    buffer_store_dwordx4 v[24:27], v122, s[36:39], s63 offen
    buffer_store_dwordx4 v[28:31], v122, s[36:39], s63 offen offset:512
    s_branch L_B0d
L_B0s:
    s_nop 3
    buffer_store_dwordx4 v[24:27], v122, s[36:39], s63 offen sc1
    buffer_store_dwordx4 v[28:31], v122, s[36:39], s63 offen offset:512 sc1
L_B0d:
    s_mov_b64 exec, -1
    s_cmp_eq_u32 s30, 1
    s_cbranch_scc0 L_Bv
    s_mul_i32 s64, s14, 20480
    s_mul_i32 s63, s28, 41984
    s_add_u32 s64, s64, s63
    s_add_u32 s64, s64, 2097152
    s_add_u32 s52, s26, s64
    s_addc_u32 s53, s27, 0
QC_15:
    s_mov_b32 s64, 9216
    buffer_load_dwordx4 v[8:11], v127, s[52:55], s64 offen offset:0 sc1
    buffer_load_dwordx4 v[24:27], v127, s[52:55], s64 offen offset:1024 sc1
    s_mov_b32 s64, 11264
    buffer_load_dwordx4 v[12:15], v127, s[52:55], s64 offen offset:0 sc1
    buffer_load_dwordx4 v[28:31], v127, s[52:55], s64 offen offset:1024 sc1
    s_mov_b32 s64, 13312
    buffer_load_dwordx4 v[16:19], v127, s[52:55], s64 offen offset:0 sc1
    buffer_load_dwordx4 v[32:35], v127, s[52:55], s64 offen offset:1024 sc1
    s_mov_b32 s64, 15360
    buffer_load_dwordx4 v[20:23], v127, s[52:55], s64 offen offset:0 sc1
    buffer_load_dwordx4 v[36:39], v127, s[52:55], s64 offen offset:1024 sc1
    s_waitcnt vmcnt(0)
    v_xor_b32 v8, s57, v8
    v_xor_b32 v9, s58, v9
    v_xor_b32 v10, s59, v10
    v_xor_b32 v11, s60, v11
    v_or3_b32 v44, v8, v9, v10
    v_or_b32 v44, v44, v11
    v_xor_b32 v12, s57, v12
    v_xor_b32 v13, s58, v13
    v_xor_b32 v14, s59, v14
    v_xor_b32 v15, s60, v15
    v_or3_b32 v44, v44, v12, v13
    v_or3_b32 v44, v44, v14, v15
    v_xor_b32 v16, s57, v16
    v_xor_b32 v17, s58, v17
    v_xor_b32 v18, s59, v18
    v_xor_b32 v19, s60, v19
    v_or3_b32 v44, v44, v16, v17
    v_or3_b32 v44, v44, v18, v19
    v_xor_b32 v20, s57, v20
    v_xor_b32 v21, s58, v21
    v_xor_b32 v22, s59, v22
    v_xor_b32 v23, s60, v23
    v_or3_b32 v44, v44, v20, v21
    v_or3_b32 v44, v44, v22, v23
    v_pk_add_f32 v[8:9], v[8:9], v[12:13]
    v_pk_add_f32 v[16:17], v[16:17], v[20:21]
    v_pk_add_f32 v[96:97], v[8:9], v[16:17]
    v_pk_add_f32 v[10:11], v[10:11], v[14:15]
    v_pk_add_f32 v[18:19], v[18:19], v[22:23]
    v_pk_add_f32 v[98:99], v[10:11], v[18:19]
    v_xor_b32 v24, s57, v24
    v_xor_b32 v25, s58, v25
    v_xor_b32 v26, s59, v26
    v_xor_b32 v27, s60, v27
    v_or3_b32 v44, v44, v24, v25
    v_or3_b32 v44, v44, v26, v27
    v_xor_b32 v28, s57, v28
    v_xor_b32 v29, s58, v29
    v_xor_b32 v30, s59, v30
    v_xor_b32 v31, s60, v31
    v_or3_b32 v44, v44, v28, v29
    v_or3_b32 v44, v44, v30, v31
    v_xor_b32 v32, s57, v32
    v_xor_b32 v33, s58, v33
    v_xor_b32 v34, s59, v34
    v_xor_b32 v35, s60, v35
    v_or3_b32 v44, v44, v32, v33
    v_or3_b32 v44, v44, v34, v35
    v_xor_b32 v36, s57, v36
    v_xor_b32 v37, s58, v37
    v_xor_b32 v38, s59, v38
    v_xor_b32 v39, s60, v39
    v_or3_b32 v44, v44, v36, v37
    v_or3_b32 v44, v44, v38, v39
    v_pk_add_f32 v[24:25], v[24:25], v[28:29]
    v_pk_add_f32 v[32:33], v[32:33], v[36:37]
    v_pk_add_f32 v[100:101], v[24:25], v[32:33]
    v_pk_add_f32 v[26:27], v[26:27], v[30:31]
    v_pk_add_f32 v[34:35], v[34:35], v[38:39]
    v_pk_add_f32 v[102:103], v[26:27], v[34:35]
    v_and_b32 v44, 255, v44
    v_cmp_ne_u32 vcc, 0, v44
    s_cbranch_vccz QC_16
    s_sub_u32 s61, s61, 1
    s_cbranch_scc0 QC_15
    s_mov_b32 s61, 0
    s_branch QC_16
QC_16:
    ds_write_b128 v127, v[96:99] offset:6144
    ds_write_b128 v127, v[100:103] offset:7168
    s_branch L_TU
L_Bv:
    s_cmp_eq_u32 s30, 0
    s_cbranch_scc0 L_TU
    s_cmp_eq_u32 s4, 9
    s_cbranch_scc1 L_G1
    v_cmp_ne_u32 vcc, s56, v62
    s_cbranch_vccz L_B1
    v_and_b32 v1, 7, v0
    v_lshlrev_b32 v1, 7, v1
    v_add_u32 v1, 1024, v1
GD_17:
    global_load_dword v2, v1, s[26:27] sc1
    s_waitcnt vmcnt(0)
    v_cmp_ne_u32 vcc, s56, v2
    s_cbranch_vccz GD_18
    s_sub_u32 s61, s61, 1
    s_cbranch_scc0 GD_17
    s_mov_b32 s61, 0
    s_branch GD_18
GD_18:
L_B1:
    s_cmp_eq_u32 s30, 0
    s_cbranch_scc0 L_TU
    s_cmp_eq_u32 s34, 0
    s_cbranch_scc1 BW_20
    s_lshl_b32 s64, s33, 4
    s_add_u32 s64, s64, 42496
    v_mov_b32 v1, 0
BW_19:
    buffer_load_dword v2, v1, s[36:39], s64 offen sc1
    s_waitcnt vmcnt(0)
    v_cmp_eq_u32 vcc, -1, v2
    s_cbranch_vccz BW_20
    s_sub_u32 s61, s61, 1
    s_cbranch_scc0 BW_19
    s_mov_b32 s61, 0
    s_branch BW_20
BW_20:
    v_add_u32 v112, 512, v136
    s_mul_i32 s63, s34, 10240
    s_add_u32 s63, s63, 114688
    s_add_u32 s40, s26, s63
    s_addc_u32 s41, s27, 0
    s_branch L_G
L_TU:
    s_cmp_lg_u32 s30, 0
    s_waitcnt lgkmcnt(0)
    s_barrier
    ds_read_b128 v[8:11], v111 offset:512
    ds_read_b128 v[12:15], v111 offset:576
    ds_read_b128 v[16:19], v111 offset:640
    ds_read_b128 v[20:23], v111 offset:704
    s_cbranch_scc1 L_TUw
    v_dot2_f32_bf16 v46, v110, v110, 0
    v_dot2_f32_bf16 v47, v110, v57, 0
    s_nop 2
    v_permlane32_swap_b32 v47, v46
    v_add_f32 v46, v46, v47
    s_nop 1
    v_add_f32_dpp v46, v46, v46 row_ror:1 row_mask:0xf bank_mask:0xf
    s_nop 1
    v_add_f32_dpp v46, v46, v46 row_ror:2 row_mask:0xf bank_mask:0xf
    s_waitcnt lgkmcnt(3)
    v_mfma_f32_16x16x32_bf16 v[24:27], a[80:83], v[8:11], 0
    v_mfma_f32_16x16x32_bf16 v[28:31], a[96:99], v[8:11], 0
    v_add_f32_dpp v46, v46, v46 row_ror:4 row_mask:0xf bank_mask:0xf
    s_waitcnt lgkmcnt(2)
    v_mfma_f32_16x16x32_bf16 v[24:27], a[84:87], v[12:15], v[24:27]
    v_mfma_f32_16x16x32_bf16 v[28:31], a[100:103], v[12:15], v[28:31]
    v_add_f32_dpp v46, v46, v46 row_ror:8 row_mask:0xf bank_mask:0xf
    s_waitcnt lgkmcnt(1)
    v_mfma_f32_16x16x32_bf16 v[24:27], a[88:91], v[16:19], v[24:27]
    v_mfma_f32_16x16x32_bf16 v[28:31], a[104:107], v[16:19], v[28:31]
    v_add_f32_dpp v46, v46, v46 row_bcast:15 row_mask:0xa bank_mask:0xf
    s_waitcnt lgkmcnt(0)
    v_mfma_f32_16x16x32_bf16 v[24:27], a[92:95], v[20:23], v[24:27]
    v_mfma_f32_16x16x32_bf16 v[28:31], a[108:111], v[20:23], v[28:31]
    v_mov_b32 v52, v46
    v_mov_b32_dpp v53, v46 row_bcast:31 row_mask:0xc bank_mask:0xf
    s_cmp_eq_u32 s14, 0
    s_cbranch_scc0 L_TUsafe
    s_mov_b64 exec, s[70:71]
    s_nop 1
    buffer_store_dwordx4 v[24:27], v122, s[36:39], 0 offen
    buffer_store_dwordx4 v[28:31], v122, s[36:39], 0 offen offset:512
    s_mov_b64 exec, s[78:79]
    buffer_store_dwordx2 v[52:53], v137, s[36:39], 0 offen
L_TUd:
    s_mov_b64 exec, -1
    s_cmp_eq_u32 s34, 0
    s_cbranch_scc0 L_exit
    s_cmp_eq_u32 s30, 0
    s_cbranch_scc0 L_B3
    s_lshl_b32 s64, s33, 4
    s_add_u32 s64, s64, 42752
    v_mov_b32 v1, 0
BW_21:
    buffer_load_dword v2, v1, s[36:39], s64 offen sc1
    s_waitcnt vmcnt(0)
    v_cmp_eq_u32 vcc, -1, v2
    s_cbranch_vccz BW_22
    s_sub_u32 s61, s61, 1
    s_cbranch_scc0 BW_21
    s_mov_b32 s61, 0
    s_branch BW_22
BW_22:
L_B3:
    v_add_u32 v112, 0, v136
    s_mul_i32 s63, s34, 10240
    s_add_u32 s63, s63, 119808
    s_add_u32 s40, s26, s63
    s_addc_u32 s41, s27, 0
L_next:
    ds_read_b128 v[96:99], v127 offset:6144
    ds_read_b128 v[100:103], v127 offset:7168
    s_add_u32 s36, s36, 43008
    s_addc_u32 s37, s37, 0
    s_sub_u32 s35, s35, 32768
    s_mov_b32 s15, s14
    s_movk_i32 s5, 320
    v_add_u32 v141, 51200, v127
    s_lshl_b32 s64, s31, 11
    s_lshl_b32 s74, s32, 8
    s_add_u32 s64, s64, s74
    s_lshl_b32 s74, s30, 6
    s_add_u32 s64, s64, s74
    s_add_u32 s64, s64, 51200
    v_add_u32 v114, s64, v135
    v_and_b32 v1, 0xf8, v128
    v_add_u32 v115, 59392, v1
    v_bfe_u32 v2, v0, 5, 1
    v_mad_u32_u24 v139, v2, s5, v1
    s_lshl_b32 s64, s29, 3
    s_add_u32 s64, s64, 59392
    v_mov_b32 v116, s64
    s_mov_b32 s70, 0x00010001
    s_mov_b32 s71, 0x00010001
    s_mov_b32 s34, 1
    s_mov_b32 s62, 0
    s_cmp_eq_u32 s30, 0
    s_cbranch_scc1 L_G
    s_branch L_TQ
L_Gretry:
    s_sub_u32 s61, s61, 1
    s_cbranch_scc0 L_Gp
    s_mov_b32 s61, 0
    s_branch L_Gok
L_QFretry:
    s_sub_u32 s61, s61, 1
    s_cbranch_scc0 L_QFp
    s_mov_b32 s61, 0
    s_branch L_QF2
L_QF2retry:
    s_sub_u32 s61, s61, 1
    s_cbranch_scc0 L_QFp
    s_mov_b32 s61, 0
    s_branch L_S
BR_1:
    buffer_store_dword v1, v1, s[36:39], s64 offen sc1
    s_branch BR_2
BR_3:
    buffer_store_dword v1, v1, s[36:39], s64 offen sc1
    s_branch BR_4
L_TQw:
    s_waitcnt lgkmcnt(3)
    v_mfma_f32_16x16x32_bf16 v[24:27], a[64:67], v[8:11], 0
    s_waitcnt lgkmcnt(2)
    v_mfma_f32_16x16x32_bf16 v[24:27], a[68:71], v[12:15], v[24:27]
    s_waitcnt lgkmcnt(1)
    v_mfma_f32_16x16x32_bf16 v[24:27], a[72:75], v[16:19], v[24:27]
    s_waitcnt lgkmcnt(0)
    v_mfma_f32_16x16x32_bf16 v[24:27], a[76:79], v[20:23], v[24:27]
    s_cmp_eq_u32 s15, 0
    s_cbranch_scc0 L_TQalt
    s_mov_b64 exec, s[70:71]
    s_nop 4
    buffer_store_dwordx4 v[24:27], v114, s[36:39], 0 offen
    s_branch L_S
L_TUw:
    s_waitcnt lgkmcnt(3)
    v_mfma_f32_16x16x32_bf16 v[24:27], a[80:83], v[8:11], 0
    v_mfma_f32_16x16x32_bf16 v[28:31], a[96:99], v[8:11], 0
    s_waitcnt lgkmcnt(2)
    v_mfma_f32_16x16x32_bf16 v[24:27], a[84:87], v[12:15], v[24:27]
    v_mfma_f32_16x16x32_bf16 v[28:31], a[100:103], v[12:15], v[28:31]
    s_waitcnt lgkmcnt(1)
    v_mfma_f32_16x16x32_bf16 v[24:27], a[88:91], v[16:19], v[24:27]
    v_mfma_f32_16x16x32_bf16 v[28:31], a[104:107], v[16:19], v[28:31]
    s_waitcnt lgkmcnt(0)
    v_mfma_f32_16x16x32_bf16 v[24:27], a[92:95], v[20:23], v[24:27]
    v_mfma_f32_16x16x32_bf16 v[28:31], a[108:111], v[20:23], v[28:31]
    s_cmp_eq_u32 s14, 0
    s_cbranch_scc0 L_TUsafe
    s_mov_b64 exec, s[70:71]
    s_nop 3
    buffer_store_dwordx4 v[24:27], v122, s[36:39], 0 offen
    buffer_store_dwordx4 v[28:31], v122, s[36:39], 0 offen offset:512
    s_branch L_TUd
L_RECsafe:
    buffer_store_dwordx4 v[36:39], v117, s[36:39], 0 offen sc1
    s_mov_b64 exec, s[68:69]
    buffer_store_dwordx2 v[34:35], v118, s[36:39], 0 offen sc1
    s_branch L_RECd
L_TUsafe:
    s_mov_b64 exec, s[70:71]
    s_cmp_lg_u32 s30, 0
    s_nop 2
    buffer_store_dwordx4 v[24:27], v122, s[36:39], 0 offen sc1
    buffer_store_dwordx4 v[28:31], v122, s[36:39], 0 offen offset:512 sc1
    s_cbranch_scc1 L_TUd
    s_mov_b64 exec, s[78:79]
    buffer_store_dwordx2 v[52:53], v137, s[36:39], 0 offen sc1
    s_branch L_TUd
L_Sbig:
    s_mov_b64 exec, -1
    v_max3_f32 v32, v24, v25, v26
    v_max_f32 v32, v32, v27
    v_max3_f32 v32, v32, v28, v29
    v_max3_f32 v32, v32, v30, v31
    v_mov_b32 v33, v32
    s_nop 1
    v_permlane32_swap_b32 v32, v33
    v_max_f32 v32, v32, v33
    v_mov_b32 v33, v32
    s_nop 1
    v_permlane16_swap_b32 v32, v33
    v_max_f32 v32, v32, v33
    v_sub_f32 v40, v24, v32
    v_sub_f32 v41, v25, v32
    v_sub_f32 v42, v26, v32
    v_sub_f32 v43, v27, v32
    v_sub_f32 v44, v28, v32
    v_sub_f32 v45, v29, v32
    v_sub_f32 v46, v30, v32
    v_sub_f32 v47, v31, v32
    v_exp_f32 v40, v40
    v_exp_f32 v41, v41
    v_exp_f32 v42, v42
    v_exp_f32 v43, v43
    v_exp_f32 v44, v44
    v_exp_f32 v45, v45
    v_exp_f32 v46, v46
    v_exp_f32 v47, v47
    v_cvt_pk_bf16_f32 v36, v40, v41
    v_cvt_pk_bf16_f32 v37, v42, v43
    v_cvt_pk_bf16_f32 v38, v44, v45
    v_cvt_pk_bf16_f32 v39, v46, v47
    s_mov_b64 exec, s[66:67]
    ds_write_b128 v131, v[36:39] offset:2560
    v_dot2_f32_bf16 v33, v36, v57, 0
    v_dot2_f32_bf16 v33, v37, v57, v33
    v_dot2_f32_bf16 v33, v38, v57, v33
    v_dot2_f32_bf16 v33, v39, v57, v33
    s_nop 2
    ds_write_b64 v132, v[32:33] offset:3584
    s_branch L_Sp
L_PVbig:
    s_nop 7
    v_mfma_f32_16x16x32_bf16 v[24:27], v[8:11], a[32:35], 0
    v_mfma_f32_16x16x32_bf16 v[28:31], v[8:11], a[36:39], 0
    v_mfma_f32_16x16x32_bf16 v[40:43], v[12:15], a[40:43], 0
    v_mfma_f32_16x16x32_bf16 v[44:47], v[12:15], a[44:47], 0
    v_mfma_f32_16x16x32_bf16 v[4:7], v[16:19], a[48:51], 0
    v_mfma_f32_16x16x32_bf16 v[8:11], v[16:19], a[52:55], 0
    v_mfma_f32_16x16x32_bf16 v[12:15], v[20:23], a[56:59], 0
    v_mfma_f32_16x16x32_bf16 v[16:19], v[20:23], a[60:63], 0
    v_max_f32_dpp v34, v32, v32 row_ror:4 row_mask:0xf bank_mask:0xf
    s_nop 1
    v_max_f32_dpp v34, v34, v34 row_ror:8 row_mask:0xf bank_mask:0xf
    v_sub_f32 v32, v32, v34
    v_exp_f32 v32, v32
    s_nop 0
    v_mul_f32 v35, v32, v33
    s_nop 1
    v_add_f32_dpp v35, v35, v35 row_ror:1 row_mask:0xf bank_mask:0xf
    v_mul_f32_dpp v36, v32, v24 row_newbcast:0 row_mask:0xf bank_mask:0xf
    v_mul_f32_dpp v37, v32, v28 row_newbcast:0 row_mask:0xf bank_mask:0xf
    v_add_f32_dpp v35, v35, v35 row_ror:2 row_mask:0xf bank_mask:0xf
    v_fmac_f32_dpp v36, v32, v40 row_newbcast:4 row_mask:0xf bank_mask:0xf
    v_fmac_f32_dpp v37, v32, v44 row_newbcast:4 row_mask:0xf bank_mask:0xf
    v_add_f32_dpp v35, v35, v35 row_ror:4 row_mask:0xf bank_mask:0xf
    v_fmac_f32_dpp v36, v32, v4 row_newbcast:8 row_mask:0xf bank_mask:0xf
    v_fmac_f32_dpp v37, v32, v8 row_newbcast:8 row_mask:0xf bank_mask:0xf
    v_add_f32_dpp v35, v35, v35 row_ror:8 row_mask:0xf bank_mask:0xf
    v_fmac_f32_dpp v36, v32, v12 row_newbcast:12 row_mask:0xf bank_mask:0xf
    v_fmac_f32_dpp v37, v32, v16 row_newbcast:12 row_mask:0xf bank_mask:0xf
    v_cvt_pk_bf16_f32 v36, v36, v37
    s_nop 1
    s_branch L_PVt
L_Obig:
    v_max_f32_dpp v6, v4, v4 quad_perm:[1,0,3,2] row_mask:0xf bank_mask:0xf
    s_nop 1
    v_max_f32_dpp v6, v6, v6 quad_perm:[2,3,0,1] row_mask:0xf bank_mask:0xf
    s_nop 1
    v_max_f32_dpp v6, v6, v6 row_half_mirror row_mask:0xf bank_mask:0xf
    v_mov_b32 v7, v6
    s_nop 1
    v_permlane32_swap_b32 v6, v7
    v_max_f32 v6, v6, v7
    v_mov_b32 v7, v6
    s_nop 1
    v_permlane16_swap_b32 v6, v7
    v_max_f32 v6, v6, v7
    v_sub_f32 v4, v4, v6
    v_exp_f32 v4, v4
    s_nop 0
    v_mul_f32 v6, v4, v5
    s_nop 1
    v_add_f32_dpp v6, v6, v6 quad_perm:[1,0,3,2] row_mask:0xf bank_mask:0xf
    s_nop 1
    v_add_f32_dpp v6, v6, v6 quad_perm:[2,3,0,1] row_mask:0xf bank_mask:0xf
    s_nop 1
    v_add_f32_dpp v6, v6, v6 row_half_mirror row_mask:0xf bank_mask:0xf
    v_mov_b32 v7, v6
    s_nop 1
    v_permlane32_swap_b32 v6, v7
    v_add_f32 v6, v6, v7
    v_mov_b32 v7, v6
    s_nop 1
    v_permlane16_swap_b32 v6, v7
    v_add_f32 v6, v6, v7
    v_rcp_f32 v6, v6
    v_mul_f32_dpp v40, v4, v24 row_newbcast:0 row_mask:0xf bank_mask:0xf
    v_fmac_f32_dpp v40, v4, v25 row_newbcast:1 row_mask:0xf bank_mask:0xf
    v_fmac_f32_dpp v40, v4, v26 row_newbcast:2 row_mask:0xf bank_mask:0xf
    v_fmac_f32_dpp v40, v4, v27 row_newbcast:3 row_mask:0xf bank_mask:0xf
    v_mul_f32_dpp v41, v4, v28 row_newbcast:0 row_mask:0xf bank_mask:0xf
    v_fmac_f32_dpp v41, v4, v29 row_newbcast:1 row_mask:0xf bank_mask:0xf
    v_fmac_f32_dpp v41, v4, v30 row_newbcast:2 row_mask:0xf bank_mask:0xf
    v_fmac_f32_dpp v41, v4, v31 row_newbcast:3 row_mask:0xf bank_mask:0xf
    v_mul_f32_dpp v42, v4, v32 row_newbcast:0 row_mask:0xf bank_mask:0xf
    v_fmac_f32_dpp v42, v4, v33 row_newbcast:1 row_mask:0xf bank_mask:0xf
    v_fmac_f32_dpp v42, v4, v34 row_newbcast:2 row_mask:0xf bank_mask:0xf
    v_fmac_f32_dpp v42, v4, v35 row_newbcast:3 row_mask:0xf bank_mask:0xf
    v_mul_f32_dpp v43, v4, v36 row_newbcast:0 row_mask:0xf bank_mask:0xf
    v_fmac_f32_dpp v43, v4, v37 row_newbcast:1 row_mask:0xf bank_mask:0xf
    v_fmac_f32_dpp v43, v4, v38 row_newbcast:2 row_mask:0xf bank_mask:0xf
    v_fmac_f32_dpp v43, v4, v39 row_newbcast:3 row_mask:0xf bank_mask:0xf
    s_branch L_Ot
L_TQalt:
    s_cmp_eq_u32 s34, 0
    s_cbranch_scc1 L_TQ0
    s_mov_b64 exec, s[70:71]
    s_cmp_lg_u32 s30, 0
    s_nop 3
    buffer_store_dwordx4 v[24:27], v114, s[36:39], 0 offen sc1
    s_cbranch_scc1 L_S
    s_mov_b64 exec, s[78:79]
    buffer_store_dwordx2 v[52:53], v116, s[36:39], 0 offen sc1
    s_mov_b64 exec, -1
    s_branch L_QFe
L_TQ0:
    s_nop 3
    v_bfi_b32 v24, v56, v24, s57
    v_bfi_b32 v25, v56, v25, s58
    v_bfi_b32 v26, v56, v26, s59
    v_bfi_b32 v27, v56, v27, s60
    s_cmp_eq_u32 s30, 0
    s_cselect_b64 s[74:75], s[78:79], 0
    s_mov_b64 exec, s[70:71]
    buffer_store_dwordx4 v[24:27], v114, s[52:55], 0 offen
    s_barrier
    s_mov_b64 exec, s[74:75]
    buffer_store_dwordx4 v[52:55], v116, s[52:55], 0 offen
    s_add_u32 s63, s29, 17920
    s_cmp_eq_u32 s30, 0
    s_cselect_b64 exec, 0xfffff, 0
    v_lshlrev_b32 v5, 3, v127
    buffer_store_byte v54, v5, s[52:55], s63 offen
    s_mov_b64 exec, -1
    s_mov_b32 s64, 20480
    v_xor_b32 v5, 0, v142
    global_load_lds_dwordx4 v5, s[6:7] nt
    s_add_u32 m0, m0, 1024
    s_add_u32 s6, s6, 32768
    s_addc_u32 s7, s7, 0
    v_xor_b32 v5, 64, v142
    global_load_lds_dwordx4 v5, s[6:7] nt
    s_add_u32 m0, m0, 1024
    s_add_u32 s6, s6, 32768
    s_addc_u32 s7, s7, 0
    v_xor_b32 v5, 128, v142
    global_load_lds_dwordx4 v5, s[6:7] nt
    s_add_u32 m0, m0, 1024
    s_add_u32 s6, s6, 32768
    s_addc_u32 s7, s7, 0
    v_xor_b32 v5, 192, v142
    global_load_lds_dwordx4 v5, s[6:7] nt
    s_add_u32 m0, m0, 1024
    s_add_u32 s6, s6, 32768
    s_addc_u32 s7, s7, 0
    v_xor_b32 v5, 0, v142
    global_load_lds_dwordx4 v5, s[6:7] nt
    s_add_u32 m0, m0, 1024
    s_add_u32 s6, s6, 32768
    s_addc_u32 s7, s7, 0
    v_xor_b32 v5, 64, v142
    global_load_lds_dwordx4 v5, s[6:7] nt
    s_add_u32 m0, m0, 1024
    s_add_u32 s6, s6, 32768
    s_addc_u32 s7, s7, 0
    v_xor_b32 v5, 128, v142
    global_load_lds_dwordx4 v5, s[6:7] nt
    s_add_u32 m0, m0, 1024
    s_add_u32 s6, s6, 32768
    s_addc_u32 s7, s7, 0
    v_xor_b32 v5, 192, v142
    global_load_lds_dwordx4 v5, s[6:7] nt
    s_mul_i32 s63, s28, 41984
    s_add_u32 s63, s63, 2117632
    s_cmp_eq_u32 s30, 0
    s_cselect_b64 s[74:75], s[78:79], 0
    s_mov_b64 exec, s[70:71]
    buffer_store_dwordx4 v[24:27], v114, s[40:43], s63 offen sc1
    s_mov_b64 exec, s[74:75]
    buffer_store_dwordx4 v[52:55], v116, s[40:43], s63 offen sc1
    s_mov_b64 exec, -1
    v_bfe_u32 v1, v0, 2, 1
    v_bfe_u32 v2, v0, 3, 1
    v_bfe_u32 v4, v0, 4, 2
    v_lshl_add_u32 v5, v4, 2, v2
    v_lshl_add_u32 v5, v1, 4, v5
    v_lshlrev_b32 v5, 7, v5
    v_bfe_u32 v6, v0, 5, 1
    v_xor_b32 v6, v6, v1
    v_and_b32 v7, 1, v4
    v_lshl_or_b32 v6, v6, 1, v7
    v_lshlrev_b32 v6, 5, v6
    v_and_b32 v7, 3, v0
    v_lshl_or_b32 v6, v7, 3, v6
    v_or_b32 v5, v5, v6
    s_lshr_b32 s63, s30, 1
    s_lshl_b32 s63, s63, 14
    s_add_u32 s63, s63, 57344
    v_add_u32 v140, s63, v5
    v_bfe_u32 v34, v0, 2, 2
    v_bfe_u32 v35, v0, 4, 2
    v_lshl_add_u32 v36, v35, 2, v34
    v_and_b32 v37, 7, v36
    v_lshlrev_b32 v37, 1, v37
    v_bfe_u32 v38, v0, 1, 1
    s_lshl_b32 s63, s30, 2
    v_or_b32 v38, s63, v38
    v_xor_b32 v37, v37, v38
    v_lshlrev_b32 v37, 4, v37
    v_lshl_add_u32 v36, v36, 8, v37
    v_and_b32 v37, 1, v0
    v_lshl_add_u32 v6, v37, 3, v36
    v_xor_b32 v7, 32, v6
    v_and_b32 v3, 15, v0
    v_xor_b32 v5, v35, v3
    v_lshlrev_b32 v5, 4, v5
    v_lshl_add_u32 v3, v3, 8, v5
    s_lshl_b32 s63, s30, 13
    s_add_u32 s63, s63, 90112
    v_add_u32 v3, s63, v3
    s_cmp_lt_u32 s29, 16
    s_cbranch_scc1 BS_23
    s_and_b32 s74, s32, 3
    s_lshr_b32 s63, s28, 1
    s_mul_i32 s63, s63, 7
    s_and_b32 s64, s28, 1
    s_lshl_b32 s75, s64, 2
    s_add_u32 s63, s63, s75
    s_add_u32 s63, s63, s74
    s_lshl_b32 s63, s63, 7
    s_mul_i32 s75, s31, 458752
    s_add_u32 s63, s63, s75
    s_add_u32 s16, s16, s63
    s_addc_u32 s17, s17, 0
    s_add_u32 s18, s18, s63
    s_addc_u32 s19, s19, 0
    s_lshl_b32 s64, s64, 2
    s_or_b32 s64, s64, s74
    s_lshr_b32 s63, s74, 1
    s_lshl_b32 s63, s63, 2
    s_add_u32 s63, s63, s31
    s_lshl_b32 s63, s63, 10
    s_and_b32 s74, s74, 1
    s_lshl_b32 s74, s74, 8
    s_add_u32 s63, s63, s74
    s_lshl_b32 s74, s30, 6
    s_add_u32 s63, s63, s74
    s_add_u32 s63, s63, 33792
    v_add_u32 v122, s63, v135
    s_lshl_b32 s63, s33, 4
    s_add_u32 s63, s63, 41984
    v_mov_b32 v137, s63
    s_mov_b32 s4, s64
    s_movk_i32 s63, 3584
    v_mul_lo_u32 v140, v123, s63
    v_add_u32 v140, v140, v124
BS_23:
    s_lshl_b32 s63, s30, 9
    v_and_b32 v5, 0x1f0, v127
    v_bfe_u32 v4, v0, 5, 1
    v_lshl_add_u32 v5, v4, 12, v5
    v_add_u32 v141, s63, v5
    s_mul_i32 s63, s30, 320
    v_add_u32 v139, s63, v136
    v_mov_b32 v111, v135
    s_mul_i32 s63, s30, 896
    v_lshlrev_b32 v2, 3, v127
    v_min_u32 v2, 768, v2
    v_add_u32 v2, s63, v2
    v_min_u32 v2, 3200, v2
    s_lshl_b32 s63, s28, 7
    s_add_u32 s63, s63, 2048
    v_mov_b32 v1, s63
    s_lshl_b32 s63, s29, 2
    s_add_u32 s63, s63, s30
    s_cmp_eq_u32 s63, 67
    s_cselect_b64 s[74:75], 1, 0
    s_mul_i32 s64, s29, 3328
    s_cmp_eq_u32 s30, 3
    s_cbranch_scc0 L_H2e
    s_mul_i32 s62, s57, 0x01010101
    s_movk_i32 s5, 17920
L_H2:
    s_load_dwordx8 s[44:51], s[52:53], s5
    s_add_u32 s5, s5, 128
    s_cmp_eq_u32 s5, 20480
    s_waitcnt lgkmcnt(0)
    s_cbranch_scc1 L_H2d
    s_xor_b32 s44, s44, s62
    s_xor_b32 s45, s45, s62
    s_xor_b32 s46, s46, s62
    s_xor_b32 s47, s47, s62
    s_xor_b32 s48, s48, s62
    s_xor_b32 s49, s49, s62
    s_xor_b32 s50, s50, s62
    s_xor_b32 s51, s51, s62
    s_or_b32 s44, s44, s45
    s_or_b32 s44, s44, s46
    s_or_b32 s44, s44, s47
    s_or_b32 s44, s44, s48
    s_or_b32 s44, s44, s49
    s_or_b32 s44, s44, s50
    s_or_b32 s44, s44, s51
    s_cbranch_scc1 L_H2
L_H2d:
    s_mov_b32 s44, 0
    s_mov_b32 s45, 128000
    s_mov_b32 s46, 256000
    s_mov_b32 s47, 384000
    s_mov_b32 s48, 512000
    s_mov_b32 s49, 640000
    s_mov_b32 s50, 768000
    s_mov_b32 s51, 896000
L_H2e:
    s_waitcnt vmcnt(8)
    s_barrier
    buffer_load_dwordx4 v[48:51], v115, s[52:55], 0 offen sc1
    buffer_load_dwordx4 v[8:11], v141, s[52:55], 0 offen sc1
    buffer_load_dwordx4 v[12:15], v141, s[52:55], 0 offen offset:2048 sc1
    s_barrier
    buffer_load_dword v60, v2, s[36:39], s64 offen sc1
    s_mov_b64 exec, s[74:75]
    global_store_dword v1, v54, s[26:27] sc1
    s_mov_b64 exec, -1
    s_cmp_ge_u32 s29, 16
    s_cbranch_scc1 L_K1
    s_lshl_b32 s63, s28, 1
    s_lshr_b32 s64, s33, 3
    s_add_u32 s63, s63, s64
    s_lshl_b32 s63, s63, 18
    s_and_b32 s64, s33, 7
    s_lshl_b32 s64, s64, 7
    s_add_u32 s63, s63, s64
    s_add_u32 s12, s12, s63
    s_addc_u32 s13, s13, 0
    v_lshl_add_u32 v4, v123, 10, v124
    s_lshl_b32 s63, s30, 10
    s_add_u32 m0, s63, 57344
    s_nop 0
    global_load_lds_dwordx4 v4, s[12:13] nt
    s_add_u32 m0, m0, 4096
    s_add_u32 s12, s12, 32768
    s_addc_u32 s13, s13, 0
    global_load_lds_dwordx4 v4, s[12:13] nt
    s_add_u32 m0, m0, 4096
    s_add_u32 s12, s12, 32768
    s_addc_u32 s13, s13, 0
    global_load_lds_dwordx4 v4, s[12:13] nt
    s_add_u32 m0, m0, 4096
    s_add_u32 s12, s12, 32768
    s_addc_u32 s13, s13, 0
    global_load_lds_dwordx4 v4, s[12:13] nt
    s_add_u32 m0, m0, 4096
    s_add_u32 s12, s12, 32768
    s_addc_u32 s13, s13, 0
    global_load_lds_dwordx4 v4, s[12:13] nt
    s_add_u32 m0, m0, 4096
    s_add_u32 s12, s12, 32768
    s_addc_u32 s13, s13, 0
    global_load_lds_dwordx4 v4, s[12:13] nt
    s_add_u32 m0, m0, 4096
    s_add_u32 s12, s12, 32768
    s_addc_u32 s13, s13, 0
    global_load_lds_dwordx4 v4, s[12:13] nt
    s_add_u32 m0, m0, 4096
    s_add_u32 s12, s12, 32768
    s_addc_u32 s13, s13, 0
    global_load_lds_dwordx4 v4, s[12:13] nt
    ds_read_b64_tr_b16 a[32:33], v6 offset:24576
    ds_read_b64_tr_b16 a[34:35], v6 offset:28672
    ds_read_b64_tr_b16 a[36:37], v7 offset:24576
    ds_read_b64_tr_b16 a[38:39], v7 offset:28672
    ds_read_b64_tr_b16 a[40:41], v6 offset:32768
    ds_read_b64_tr_b16 a[42:43], v6 offset:36864
    ds_read_b64_tr_b16 a[44:45], v7 offset:32768
    ds_read_b64_tr_b16 a[46:47], v7 offset:36864
    ds_read_b64_tr_b16 a[48:49], v6 offset:40960
    ds_read_b64_tr_b16 a[50:51], v6 offset:45056
    ds_read_b64_tr_b16 a[52:53], v7 offset:40960
    ds_read_b64_tr_b16 a[54:55], v7 offset:45056
    ds_read_b64_tr_b16 a[56:57], v6 offset:49152
    ds_read_b64_tr_b16 a[58:59], v6 offset:53248
    ds_read_b64_tr_b16 a[60:61], v7 offset:49152
    ds_read_b64_tr_b16 a[62:63], v7 offset:53248
    s_waitcnt vmcnt(13)
    v_xor_b32 v5, 0, v3
    ds_read_b128 a[0:3], v5 offset:0
    ds_read_b128 a[16:19], v5 offset:4096
    v_xor_b32 v5, 64, v3
    ds_read_b128 a[4:7], v5 offset:0
    ds_read_b128 a[20:23], v5 offset:4096
    v_xor_b32 v5, 128, v3
    ds_read_b128 a[8:11], v5 offset:0
    ds_read_b128 a[24:27], v5 offset:4096
    v_xor_b32 v5, 192, v3
    ds_read_b128 a[12:15], v5 offset:0
    ds_read_b128 a[28:31], v5 offset:4096
    s_waitcnt vmcnt(10)
    s_branch L_Q01
L_K1:
    s_lshl_b32 s63, s28, 1
    s_lshr_b32 s64, s33, 3
    s_add_u32 s63, s63, s64
    s_lshl_b32 s63, s63, 18
    s_and_b32 s64, s33, 7
    s_lshl_b32 s64, s64, 7
    s_add_u32 s63, s63, s64
    s_add_u32 s12, s12, s63
    s_addc_u32 s13, s13, 0
    v_and_b32 v4, 15, v0
    s_mul_i32 s63, s30, 16
    s_add_u32 s63, s63, 192
    v_add_u32 v4, s63, v4
    v_lshlrev_b32 v4, 10, v4
    global_load_dword v61, v4, s[12:13] nt
    ds_read_b64_tr_b16 a[32:33], v6 offset:24576
    ds_read_b64_tr_b16 a[34:35], v6 offset:28672
    ds_read_b64_tr_b16 a[36:37], v7 offset:24576
    ds_read_b64_tr_b16 a[38:39], v7 offset:28672
    ds_read_b64_tr_b16 a[40:41], v6 offset:32768
    ds_read_b64_tr_b16 a[42:43], v6 offset:36864
    ds_read_b64_tr_b16 a[44:45], v7 offset:32768
    ds_read_b64_tr_b16 a[46:47], v7 offset:36864
    ds_read_b64_tr_b16 a[48:49], v6 offset:40960
    ds_read_b64_tr_b16 a[50:51], v6 offset:45056
    ds_read_b64_tr_b16 a[52:53], v7 offset:40960
    ds_read_b64_tr_b16 a[54:55], v7 offset:45056
    ds_read_b64_tr_b16 a[56:57], v6 offset:49152
    ds_read_b64_tr_b16 a[58:59], v6 offset:53248
    ds_read_b64_tr_b16 a[60:61], v7 offset:49152
    ds_read_b64_tr_b16 a[62:63], v7 offset:53248
    s_waitcnt vmcnt(6)
    v_xor_b32 v5, 0, v3
    ds_read_b128 a[0:3], v5 offset:0
    ds_read_b128 a[16:19], v5 offset:4096
    v_xor_b32 v5, 64, v3
    ds_read_b128 a[4:7], v5 offset:0
    ds_read_b128 a[20:23], v5 offset:4096
    v_xor_b32 v5, 128, v3
    ds_read_b128 a[8:11], v5 offset:0
    ds_read_b128 a[24:27], v5 offset:4096
    v_xor_b32 v5, 192, v3
    ds_read_b128 a[12:15], v5 offset:0
    ds_read_b128 a[28:31], v5 offset:4096
    s_waitcnt vmcnt(3)
L_Q01:
    v_xor_b32 v8, s57, v8
    v_xor_b32 v9, s58, v9
    v_xor_b32 v10, s59, v10
    v_xor_b32 v11, s60, v11
    v_or3_b32 v44, v8, v9, v10
    v_or_b32 v44, v44, v11
    v_xor_b32 v12, s57, v12
    v_xor_b32 v13, s58, v13
    v_xor_b32 v14, s59, v14
    v_xor_b32 v15, s60, v15
    v_or3_b32 v44, v44, v12, v13
    v_or3_b32 v44, v44, v14, v15
    v_pk_add_f32 v[8:9], v[8:9], v[12:13]
    v_pk_add_f32 v[10:11], v[10:11], v[14:15]
    v_xor_b32 v45, s56, v50
    v_and_or_b32 v44, v44, v58, v45
    v_permlane32_swap_b32 v8, v10
    v_permlane32_swap_b32 v9, v11
    v_cmp_ne_u32 vcc, 0, v44
    v_add_f32 v8, v8, v10
    v_add_f32 v9, v9, v11
    v_cvt_pk_bf16_f32 v8, v8, v9
    ds_write_b32 v139, v8 offset:1280
    s_cbranch_vccnz L_Q0retry
L_Q0ok:
    v_cmp_ne_u32 vcc, v51, v55
    s_cmp_lg_u64 vcc, 0
    s_cselect_b32 s14, 1, 0
L_Q0d:
    s_cmp_lt_u32 s29, 16
    s_cbranch_scc1 L_Q0a
    v_lshlrev_b32 v5, 3, v127
    v_and_b32 v5, 0x380, v5
    global_load_dword v63, v5, s[26:27] offset:2048 sc1
L_Q0a:
    s_cmp_eq_u32 s30, 0
    s_cbranch_scc0 L_S
    s_cmp_eq_u32 s14, 0
    s_cbranch_scc0 L_slow
L_slowdone:
    s_cmp_eq_u32 s29, 0
    s_cbranch_scc0 L_S
    s_lshl_b32 s63, s28, 7
    s_add_u32 s63, s63, 1024
    v_mov_b32 v9, s63
    s_mov_b64 exec, 1
    global_store_dword v9, v54, s[26:27] sc1
    s_branch L_S
L_Q0p:
    buffer_load_dwordx4 v[48:51], v115, s[52:55], 0 offen sc1
    buffer_load_dwordx4 v[8:11], v141, s[52:55], 0 offen sc1
    buffer_load_dwordx4 v[12:15], v141, s[52:55], 0 offen offset:2048 sc1
    s_waitcnt vmcnt(0)
    s_branch L_Q01
L_Q0retry:
    s_sub_u32 s77, s77, 1
    s_cmp_eq_u32 s77, 8
    s_cbranch_scc0 QR_24x
QR_24x:
    s_cmp_eq_u32 s77, 0
    s_cbranch_scc0 QR_24
    s_add_u32 s52, s52, 20480
    s_addc_u32 s53, s53, 0
QR_24:
    s_sub_u32 s61, s61, 1
    s_cbranch_scc0 L_Q0p
    s_mov_b32 s61, 0
    s_branch L_Q0ok
L_slow:
    s_mul_i32 s63, s29, 3328
    v_mov_b32 v12, -1
    v_mov_b32 v13, -1
    v_mov_b32 v14, -1
    v_mov_b32 v15, -1
    v_min_u32 v9, 240, v127
    buffer_store_dwordx4 v[12:15], v127, s[36:39], s63 offen sc1
    buffer_store_dwordx4 v[12:15], v127, s[36:39], s63 offen offset:1024 sc1
    buffer_store_dwordx4 v[12:15], v127, s[36:39], s63 offen offset:2048 sc1
    buffer_store_dwordx4 v[12:15], v9, s[36:39], s63 offen offset:3072 sc1
    s_mul_i32 s63, s28, 41984
    s_add_u32 s63, s63, 2114560
    s_lshl_b32 s64, s29, 4
    s_add_u32 s64, s64, s63
    v_mov_b32 v9, s64
    s_waitcnt vmcnt(0)
    s_mov_b64 exec, 1
    global_store_dword v9, v54, s[26:27] sc1
    s_mov_b64 exec, -1
    v_and_b32 v9, 0x1f0, v127
    v_add_u32 v9, s63, v9
L_slowp:
    global_load_dword v8, v9, s[26:27] sc1
    s_waitcnt vmcnt(0)
    v_cmp_ne_u32 vcc, s56, v8
    s_cbranch_vccz L_slowdone
    s_sub_u32 s61, s61, 1
    s_cbranch_scc0 L_slowp
    s_mov_b32 s61, 0
    s_branch L_slowdone
L_Oretry:
    s_sub_u32 s61, s61, 1
    s_cbranch_scc0 L_Op
    s_mov_b32 s61, 0
    s_branch L_O2
L_O2retry:
    s_sub_u32 s61, s61, 1
    s_cbranch_scc0 L_Op
    s_mov_b32 s61, 0
    s_branch L_Ook
L_Dretry:
    buffer_load_dwordx2 v[48:49], v137, s[36:39], 0 offen sc1
    buffer_load_dwordx4 v[64:67], v121, s[36:39], 0 offen offset:0 sc1
    buffer_load_dwordx4 v[68:71], v121, s[36:39], 0 offen offset:1024 sc1
    buffer_load_dwordx4 v[72:75], v121, s[36:39], 0 offen offset:2048 sc1
    buffer_load_dwordx4 v[76:79], v121, s[36:39], 0 offen offset:3072 sc1
    s_waitcnt vmcnt(9)
    v_cmp_eq_u32 vcc, -1, v50
    v_add_f32_dpp v46, v50, v50 quad_perm:[1,0,3,2] row_mask:0xf bank_mask:0xf
    v_add_f32_dpp v47, v51, v51 quad_perm:[1,0,3,2] row_mask:0xf bank_mask:0xf
    s_cbranch_vccnz L_DretryB
    v_add_f32_dpp v46, v46, v46 quad_perm:[2,3,0,1] row_mask:0xf bank_mask:0xf
    v_add_f32_dpp v47, v47, v47 quad_perm:[2,3,0,1] row_mask:0xf bank_mask:0xf
    v_mul_f32 v45, 0x3b000000, v46
    v_mul_f32 v46, 0xbb000000, v47
    v_fma_f32 v45, -v46, v46, v45
    v_max_f32 v45, 0, v45
    v_add_f32 v45, 0x3727c5ac, v45
    v_rcp_f32 v45, v45
    s_waitcnt vmcnt(7)
    v_max_u32 v44, v80, v84
    v_pk_fma_f32 v[40:41], v[104:105], v[46:47], v[80:81] op_sel_hi:[1,0,1]
    v_pk_fma_f32 v[42:43], v[106:107], v[46:47], v[82:83] op_sel_hi:[1,0,1]
    v_pk_add_f32 v[40:41], v[40:41], v[84:85]
    v_pk_add_f32 v[42:43], v[42:43], v[86:87]
    s_waitcnt vmcnt(6)
    v_pk_add_f32 v[40:41], v[40:41], v[88:89]
    v_pk_add_f32 v[42:43], v[42:43], v[90:91]
    v_max_u32 v44, v44, v88
    s_waitcnt vmcnt(5)
    v_pk_add_f32 v[40:41], v[40:41], v[92:93]
    v_pk_add_f32 v[42:43], v[42:43], v[94:95]
    v_max_u32 v44, v44, v92
    v_cmp_eq_u32 vcc, -1, v44
    v_permlane32_swap_b32 v40, v42
    v_permlane32_swap_b32 v41, v43
    v_mul_f32 v40, v40, v45
    v_mul_f32 v41, v41, v45
    v_mul_f32 v40, v40, v42
    v_mul_f32 v41, v41, v43
    v_cvt_pk_bf16_f32 v40, v40, v41
    ds_write_b32 v136, v40 offset:1024
    s_cbranch_vccnz L_DretryB
    s_branch L_Dm
L_DretryB:
    s_sub_u32 s61, s61, 1
    s_cbranch_scc0 L_DpB
    s_mov_b32 s61, 0
    s_branch L_Dm
L_exit:
L_end:
    s_endpgm
.section .rodata,"a"
.p2align 6
.amdhsa_kernel interleave_layers__sliding_block_cached__glu_gated_bilinear__decode_kernel
  .amdhsa_next_free_vgpr 320
  .amdhsa_next_free_sgpr 102
  .amdhsa_accum_offset 144
  .amdhsa_group_segment_fixed_size 0
  .amdhsa_kernarg_size 96
  .amdhsa_user_sgpr_count 2
  .amdhsa_user_sgpr_kernarg_segment_ptr 1
  .amdhsa_system_sgpr_workgroup_id_x 1
  .amdhsa_float_denorm_mode_32 3
.end_amdhsa_kernel
```
